```python
import torch

def _softmax(x, axis=-1):
    return torch.softmax(x, dim=axis)

def _gelu(x):
    return torch.nn.functional.gelu(x, approximate='tanh')

def _silu(x):
    return torch.nn.functional.silu(x)

def _sigmoid(x):
    return torch.sigmoid(x)

def _layernorm(x, axis=-1, eps=1e-05):
    m = x.mean(dim=axis, keepdim=True)
    v = x.var(dim=axis, keepdim=True, unbiased=False)
    return (x - m) / torch.sqrt(v + eps)

def _scatter_add(tgt, idx, src, axis=0):
    return tgt.clone().index_add_(axis, idx, src)

def _segment_sum(src, seg, n):
    out = torch.zeros((n,) + src.shape[1:], dtype=src.dtype)
    return out.index_add_(0, seg, src)

def _pad(x, pw):
    flat = tuple((v for pair in reversed(pw) for v in pair))
    return torch.nn.functional.pad(x, flat)
kernel_name = 'gated_mix__linear_attn_block__mixer_gmlp__prompt'

def setup_inputs():

    _w = lambda a: (lambda t: t.to(torch.bfloat16) if t.is_floating_point() else t)(torch.as_tensor(a))

    def _A_setup():
        B, S, D = (1, 2048, 512)
        return {'x': _w((lambda *s: torch.randn(*s, dtype=torch.bfloat16) * 0.05)(B, S, D)), 'wqkv': _w((lambda *s: torch.randn(*s, dtype=torch.bfloat16) * 1.6)(D, 3 * D)), 'wo': _w((lambda *s: torch.randn(*s, dtype=torch.bfloat16) * 0.2)(D, D))}
    _A_in = _A_setup()

    def _B_setup():
        B, S, D, F = (1, 2048, 512, 1376)
        Fh = F // 2
        return {'x': _w((lambda *s: torch.randn(*s, dtype=torch.bfloat16) * 0.05)(B, S, D)), 'w_in': _w((lambda *s: torch.randn(*s, dtype=torch.bfloat16) * 0.4)(D, 2 * Fh)), 'w_sp': _w(0.01 * (lambda *s: torch.randn(*s, dtype=torch.bfloat16) * 0.4)(S, S)), 'b_sp': _w(1.0 + 0.01 * (lambda *s: torch.randn(*s, dtype=torch.bfloat16) * 0.05)(S)), 'w_out': _w((lambda *s: torch.randn(*s, dtype=torch.bfloat16) * 0.05)(Fh, D))}
    _B_in = _B_setup()
    return {'A_x': _A_in['x'], 'A_wqkv': _A_in['wqkv'], 'A_wo': _A_in['wo'], 'B_x': _B_in['x'], 'B_w_in': _B_in['w_in'], 'B_w_sp': _B_in['w_sp'], 'B_b_sp': _B_in['b_sp'], 'B_w_out': _B_in['w_out'], 'gate_w': _w((lambda *s: torch.randn(*s, dtype=torch.bfloat16) * 0.05)(512) * 16.0)}

def reference(A_x, A_wqkv, A_wo, B_x, B_w_in, B_w_sp, B_b_sp, B_w_out, gate_w):

    def _A_ref(x, wqkv, wo):
        B, S, D = x.shape
        H = 32
        Dh = D // H
        qkv = (lambda x, *d: x.permute(*d))((x @ wqkv).reshape(B, S, 3, H, Dh), 2, 0, 3, 1, 4)
        q, k, v = (qkv[0], qkv[1], qkv[2])
        phi = lambda t: torch.where(t > 0, t + 1, torch.exp(t)) + 1e-06
        pq, pk = (phi(q), phi(k))
        kv = torch.einsum('bhsd,bhse->bhde', pk, v)
        z = torch.einsum('bhsd->bhd', pk)
        num = torch.einsum('bhqd,bhde->bhqe', pq, kv)
        den = torch.einsum('bhqd,bhd->bhq', pq, z)[..., None] + 1e-06
        o = num / den
        return (lambda x, *d: x.permute(*d))(o, 0, 2, 1, 3).reshape(B, S, D) @ wo

    def _B_ref(x, w_in, w_sp, b_sp, w_out):
        B, S, D = x.shape
        F = w_in.shape[-1]
        Fh = F // 2
        z = _gelu(torch.einsum('bsd,df->bsf', x, w_in))
        z1 = z[..., :Fh].clone()
        z2 = _layernorm(z[..., Fh:], axis=-1)
        g = torch.einsum('ts,bsf->btf', w_sp, z2) + b_sp[None, :, None]
        return torch.einsum('bsf,fd->bsd', z1 * g, w_out)
    x = A_x
    g = _sigmoid((x * gate_w).sum(-1, keepdims=True))
    a = _A_ref(x, A_wqkv, A_wo)
    b = _B_ref(x, B_w_in, B_w_sp, B_b_sp, B_w_out)
    return g * a + (1 - g) * b
```

```asm
; @launch grid=(256,1,1) block=(512,1,1) lds=163840
.amdgcn_target "amdgcn-amd-amdhsa--gfx950"
.text
.globl gated_mix__linear_attn_block__mixer_gmlp__prompt_kernel
.p2align 8
.type gated_mix__linear_attn_block__mixer_gmlp__prompt_kernel,@function
gated_mix__linear_attn_block__mixer_gmlp__prompt_kernel:
s_cmp_ge_u32 s2, 256
s_cbranch_scc1 k_exit
s_load_dwordx16 s[16:31], s[0:1], 0
s_load_dwordx8 s[32:39], s[0:1], 64
v_lshrrev_b32 v1, 6, v0
v_and_b32 v0, 63, v0
v_readfirstlane_b32 s6, v1
s_nop 3
s_and_b32 s7, s6, 3
s_lshr_b32 s8, s6, 2
s_lshl_b32 s74, s6, 11
s_lshl_b32 s75, s6, 10
s_and_b32 s60, s2, 7
s_lshr_b32 s61, s2, 3
s_and_b32 s62, s60, 1
s_lshl_b32 s62, s62, 3
s_and_b32 s63, s61, 7
s_add_u32 s9, s62, s63
s_lshr_b32 s62, s60, 1
s_lshl_b32 s62, s62, 1
s_lshr_b32 s63, s61, 3
s_add_u32 s10, s62, s63
s_add_u32 s64, s10, 6
s_cmp_ge_u32 s63, 2
s_cselect_b32 s10, s64, s10
s_and_b32 s62, s61, 7
s_lshr_b32 s63, s61, 3
s_add_u32 s62, s62, s63
s_and_b32 s62, s62, 7
s_mul_i32 s15, s62, 1
v_lshrrev_b32 v115, 3, v0
v_and_b32 v116, 7, v0
v_lshrrev_b32 v117, 4, v0
v_and_b32 v118, 15, v0
s_lshl_b32 s60, s9, 17
s_lshl_b32 s61, s6, 14
s_add_u32 s60, s60, s61
v_xor_b32 v92, v116, v117
v_lshlrev_b32 v92, 4, v92
v_lshl_add_u32 v92, v115, 10, v92
v_add_u32 v92, s60, v92
v_xor_b32 v93, 64, v92
v_add_u32 v93, 7168, v93
s_waitcnt lgkmcnt(0)
s_mov_b32 s40, s16
s_and_b32 s41, s17, 0xffff
s_mov_b32 s42, 0x200000
s_mov_b32 s43, 0x00020000
s_lshl_b32 s99, s15, 7
s_add_u32 m0, s74, 0
s_nop 0
buffer_load_dwordx4 v92, s[40:43], s99 offen offset:0  lds
buffer_load_dwordx4 v93, s[40:43], s99 offen offset:1024  lds
s_add_u32 s99, s99, 128
s_cmp_eq_u32 s99, 1024
s_cselect_b32 s99, 0, s99
s_cmp_lg_u32 s6, 7
s_cbranch_scc1 if_1
s_getpc_b64 s[62:63]
k_pc:
s_lshr_b32 s64, s2, 3
s_mul_i32 s64, s64, 14
v_add_u32 v1, s64, v0
v_lshlrev_b32 v1, 7, v1
s_mov_b32 s65, k_code_end-k_pc-4
v_cmp_gt_u32 vcc, s65, v1
s_mov_b64 s[68:69], exec
s_mov_b64 exec, 16383
s_nop 1
s_and_b64 exec, exec, vcc
s_cbranch_execz cpz_2
global_load_dword v1, v1, s[62:63]
cpz_2:
s_mov_b64 exec, s[68:69]
if_1:
s_cmp_ge_u32 s10, 8
s_cbranch_scc1 p1win_3
s_mov_b32 s44, s18
s_and_b32 s45, s19, 0xffff
s_mov_b32 s46, 0x180000
s_mov_b32 s47, 0x00020000
s_movk_i32 s72, 896
s_movk_i32 s73, 3072
s_mul_i32 s100, s15, 196608
s_mov_b32 s101, s100
s_and_b32 s62, s6, 1
s_lshl_b32 s62, s62, 2
v_lshrrev_b32 v119, 1, v118
v_xor_b32 v119, v119, v117
v_xor_b32 v119, s62, v119
v_and_b32 v120, 1, v0
v_lshlrev_b32 v94, 5, v119
v_lshl_add_u32 v94, v120, 4, v94
v_lshrrev_b32 v119, 2, v119
v_mad_u32_u24 v94, v119, s72, v94
v_mad_u32_u24 v94, v117, s73, v94
s_mul_i32 s61, s6, 24576
s_lshl_b32 s63, s10, 7
s_add_u32 s61, s61, s63
s_add_u32 s63, s61, 1024
v_add_u32 v94, s63, v94
v_add_u32 v95, 11264, v94
s_add_u32 m0, s74, 16384
s_nop 0
buffer_load_dwordx4 v94, s[44:47], s100 offen offset:0  lds
buffer_load_dwordx4 v95, s[44:47], s100 offen offset:1024  lds
s_add_u32 s100, s100, 196608
s_cmp_eq_u32 s100, 1572864
s_cselect_b32 s100, 0, s100
s_add_u32 m0, s74, 32768
s_nop 0
buffer_load_dwordx4 v92, s[40:43], s99 offen offset:0  lds
buffer_load_dwordx4 v93, s[40:43], s99 offen offset:1024  lds
s_add_u32 s99, s99, 128
s_cmp_eq_u32 s99, 1024
s_cselect_b32 s99, 0, s99
s_add_u32 m0, s74, 49152
s_nop 0
buffer_load_dwordx4 v94, s[44:47], s100 offen offset:0  lds
buffer_load_dwordx4 v95, s[44:47], s100 offen offset:1024  lds
s_add_u32 s100, s100, 196608
s_cmp_eq_u32 s100, 1572864
s_cselect_b32 s100, 0, s100
s_mov_b32 s48, s38
s_and_b32 s49, s39, 0xffff
s_mov_b32 s50, 0xf10000
s_mov_b32 s51, 0x00020000
s_mov_b32 s92, s36
s_and_b32 s93, s37, 0xffff
s_mov_b32 s94, 0x100
s_mov_b32 s95, 0x00020000
s_mov_b32 s52, s26
s_and_b32 s53, s27, 0xffff
s_mov_b32 s54, 0x800000
s_mov_b32 s55, 0x00020000
s_cmp_lg_u32 s2, 0
s_cbranch_scc1 init_5
s_cmp_lg_u32 s6, 0
s_cbranch_scc1 init_5
v_lshlrev_b32 v2, 8, v0
v_mov_b32 v3, 0
s_mov_b32 s60, 15728640
buffer_store_dword v3, v2, s[48:51], s60 offen sc1
s_add_u32 s60, s60, 16384
buffer_store_dword v3, v2, s[48:51], s60 offen sc1
init_5:
s_cmp_lg_u32 s6, 0
s_cbranch_scc1 if_6
v_mov_b32 v2, 159744
v_mov_b32 v3, 0
ds_write_b32 v2, v3 offset:0
ds_write_b32 v2, v3 offset:4
ds_write_b32 v2, v3 offset:8
ds_write_b32 v2, v3 offset:12
ds_write_b32 v2, v3 offset:16
s_waitcnt lgkmcnt(0)
if_6:
s_and_b32 s60, s2, 7
s_lshr_b32 s61, s2, 3
s_lshr_b32 s62, s60, 1
s_lshl_b32 s62, s62, 3
s_and_b32 s63, s61, 7
s_add_u32 s96, s62, s63
s_lshl_b32 s62, s60, 2
s_and_b32 s63, s61, 3
s_add_u32 s97, s62, s63
s_lshr_b32 s98, s61, 2
s_lshr_b32 s63, s61, 3
s_mov_b32 s62, s63
s_and_b32 s5, s62, 3
s_and_b32 s62, s5, 1
s_lshl_b32 s5, s62, 1
s_and_b32 s62, s6, 1
s_lshl_b32 s62, s62, 1
v_lshrrev_b32 v119, 1, v116
v_and_b32 v96, 1, v117
v_xor_b32 v119, v119, v96
v_xor_b32 v119, s62, v119
v_lshlrev_b32 v119, 5, v119
v_and_b32 v120, 1, v0
v_lshl_add_u32 v119, v120, 4, v119
v_mad_u32_u24 v119, v115, s73, v119
s_mul_i32 s61, s6, 24576
s_lshl_b32 s63, s10, 7
s_add_u32 s61, s61, s63
v_add_u32 v96, s61, v119
v_lshrrev_b32 v119, 1, v118
v_xor_b32 v119, v119, v117
v_lshlrev_b32 v119, 4, v119
v_lshl_add_u32 v119, v118, 7, v119
s_lshl_b32 s61, s7, 12
v_add_u32 v100, s61, v119
v_xor_b32 v101, 64, v100
v_lshrrev_b32 v109, 2, v118
v_and_b32 v110, 1, v117
v_lshl_or_b32 v110, v110, 2, v109
v_and_b32 v111, 3, v118
v_lshlrev_b32 v111, 3, v111
v_lshl_add_u32 v109, v117, 3, v109
v_lshl_add_u32 v120, v109, 8, v111
s_lshl_b32 s61, s8, 1
v_xor_b32 v119, s61, v110
v_mov_b32 v102, v119
v_lshl_add_u32 v102, v102, 5, v120
v_xor_b32 v103, 1, v119
v_lshl_add_u32 v103, v103, 5, v120
v_xor_b32 v104, 4, v119
v_lshl_add_u32 v104, v104, 5, v120
v_xor_b32 v105, 5, v119
v_lshl_add_u32 v105, v105, 5, v120
v_lshrrev_b32 v120, 3, v118
v_and_b32 v119, 1, v117
v_lshl_or_b32 v120, v119, 1, v120
v_xor_b32 v120, s61, v120
v_lshl_add_u32 v119, v109, 7, v111
v_lshl_add_u32 v106, v120, 5, v119
v_xor_b32 v107, 32, v106
s_waitcnt vmcnt(4)
s_barrier
ds_read_b128 a[0:3], v100 offset:0
ds_read_b128 a[64:67], v100 offset:2048
ds_read_b64_tr_b16 v[60:61], v102 offset:16384
ds_read_b64_tr_b16 v[62:63], v102 offset:17408
ds_read_b64_tr_b16 v[64:65], v103 offset:16384
ds_read_b64_tr_b16 v[66:67], v103 offset:17408
ds_read_b64_tr_b16 v[68:69], v104 offset:16384
ds_read_b64_tr_b16 v[70:71], v104 offset:17408
ds_read_b64_tr_b16 v[72:73], v105 offset:16384
ds_read_b64_tr_b16 v[74:75], v105 offset:17408
s_add_u32 m0, s74, 65536
s_nop 0
buffer_load_dwordx4 v92, s[40:43], s99 offen offset:0  lds
buffer_load_dwordx4 v93, s[40:43], s99 offen offset:1024  lds
s_add_u32 s99, s99, 128
s_cmp_eq_u32 s99, 1024
s_cselect_b32 s99, 0, s99
s_waitcnt lgkmcnt(0)
v_mfma_f32_16x16x32_bf16 v[4:7], a[0:3], v[60:63], 0
ds_read_b128 a[4:7], v101 offset:0
ds_read_b128 a[68:71], v101 offset:2048
v_mfma_f32_16x16x32_bf16 v[8:11], a[64:67], v[60:63], 0
ds_read_b64_tr_b16 v[76:77], v102 offset:24576
ds_read_b64_tr_b16 v[78:79], v102 offset:25600
v_mfma_f32_16x16x32_bf16 v[12:15], a[0:3], v[64:67], 0
ds_read_b64_tr_b16 v[80:81], v103 offset:24576
ds_read_b64_tr_b16 v[82:83], v103 offset:25600
s_add_u32 m0, s74, 81920
s_nop 0
buffer_load_dwordx4 v94, s[44:47], s100 offen offset:0  lds
v_mfma_f32_16x16x32_bf16 v[16:19], a[64:67], v[64:67], 0
ds_read_b64_tr_b16 v[84:85], v104 offset:24576
ds_read_b64_tr_b16 v[86:87], v104 offset:25600
v_mfma_f32_16x16x32_bf16 v[20:23], a[0:3], v[68:71], 0
ds_read_b64_tr_b16 v[88:89], v105 offset:24576
ds_read_b64_tr_b16 v[90:91], v105 offset:25600
v_mfma_f32_16x16x32_bf16 v[24:27], a[64:67], v[68:71], 0
v_mfma_f32_16x16x32_bf16 v[28:31], a[0:3], v[72:75], 0
buffer_load_dwordx4 v95, s[44:47], s100 offen offset:1024  lds
s_add_u32 s100, s100, 196608
s_cmp_eq_u32 s100, 1572864
s_cselect_b32 s100, 0, s100
v_mfma_f32_16x16x32_bf16 v[32:35], a[64:67], v[72:75], 0
s_waitcnt lgkmcnt(0)
s_waitcnt vmcnt(4)
s_barrier
v_mfma_f32_16x16x32_bf16 v[4:7], a[4:7], v[76:79], v[4:7]
ds_read_b128 a[8:11], v100 offset:32768
ds_read_b128 a[72:75], v100 offset:34816
v_mfma_f32_16x16x32_bf16 v[8:11], a[68:71], v[76:79], v[8:11]
ds_read_b64_tr_b16 v[60:61], v102 offset:49152
ds_read_b64_tr_b16 v[62:63], v102 offset:50176
v_mfma_f32_16x16x32_bf16 v[12:15], a[4:7], v[80:83], v[12:15]
ds_read_b64_tr_b16 v[64:65], v103 offset:49152
ds_read_b64_tr_b16 v[66:67], v103 offset:50176
s_add_u32 m0, s74, 98304
s_nop 0
buffer_load_dwordx4 v92, s[40:43], s99 offen offset:0  lds
v_mfma_f32_16x16x32_bf16 v[16:19], a[68:71], v[80:83], v[16:19]
ds_read_b64_tr_b16 v[68:69], v104 offset:49152
ds_read_b64_tr_b16 v[70:71], v104 offset:50176
v_mfma_f32_16x16x32_bf16 v[20:23], a[4:7], v[84:87], v[20:23]
ds_read_b64_tr_b16 v[72:73], v105 offset:49152
ds_read_b64_tr_b16 v[74:75], v105 offset:50176
v_mfma_f32_16x16x32_bf16 v[24:27], a[68:71], v[84:87], v[24:27]
v_mfma_f32_16x16x32_bf16 v[28:31], a[4:7], v[88:91], v[28:31]
buffer_load_dwordx4 v93, s[40:43], s99 offen offset:1024  lds
s_add_u32 s99, s99, 128
s_cmp_eq_u32 s99, 1024
s_cselect_b32 s99, 0, s99
v_mfma_f32_16x16x32_bf16 v[32:35], a[68:71], v[88:91], v[32:35]
s_waitcnt lgkmcnt(0)
v_mfma_f32_16x16x32_bf16 v[4:7], a[8:11], v[60:63], v[4:7]
ds_read_b128 a[12:15], v101 offset:32768
ds_read_b128 a[76:79], v101 offset:34816
v_mfma_f32_16x16x32_bf16 v[8:11], a[72:75], v[60:63], v[8:11]
ds_read_b64_tr_b16 v[76:77], v102 offset:57344
ds_read_b64_tr_b16 v[78:79], v102 offset:58368
v_mfma_f32_16x16x32_bf16 v[12:15], a[8:11], v[64:67], v[12:15]
ds_read_b64_tr_b16 v[80:81], v103 offset:57344
ds_read_b64_tr_b16 v[82:83], v103 offset:58368
s_add_u32 m0, s74, 114688
s_nop 0
buffer_load_dwordx4 v94, s[44:47], s100 offen offset:0  lds
v_mfma_f32_16x16x32_bf16 v[16:19], a[72:75], v[64:67], v[16:19]
ds_read_b64_tr_b16 v[84:85], v104 offset:57344
ds_read_b64_tr_b16 v[86:87], v104 offset:58368
v_mfma_f32_16x16x32_bf16 v[20:23], a[8:11], v[68:71], v[20:23]
ds_read_b64_tr_b16 v[88:89], v105 offset:57344
ds_read_b64_tr_b16 v[90:91], v105 offset:58368
v_mfma_f32_16x16x32_bf16 v[24:27], a[72:75], v[68:71], v[24:27]
v_mfma_f32_16x16x32_bf16 v[28:31], a[8:11], v[72:75], v[28:31]
buffer_load_dwordx4 v95, s[44:47], s100 offen offset:1024  lds
s_add_u32 s100, s100, 196608
s_cmp_eq_u32 s100, 1572864
s_cselect_b32 s100, 0, s100
v_mfma_f32_16x16x32_bf16 v[32:35], a[72:75], v[72:75], v[32:35]
s_waitcnt lgkmcnt(0)
s_waitcnt vmcnt(4)
s_barrier
v_add_u32 v109, 81920, v102
v_add_u32 v110, 81920, v103
v_add_u32 v111, 81920, v104
v_add_u32 v112, 81920, v105
v_add_u32 v113, 65536, v100
v_add_u32 v114, 65536, v101
v_mfma_f32_16x16x32_bf16 v[4:7], a[12:15], v[76:79], v[4:7]
ds_read_b128 a[16:19], v113 offset:0
ds_read_b128 a[80:83], v113 offset:2048
v_mfma_f32_16x16x32_bf16 v[8:11], a[76:79], v[76:79], v[8:11]
ds_read_b64_tr_b16 v[60:61], v109 offset:0
ds_read_b64_tr_b16 v[62:63], v109 offset:1024
v_mfma_f32_16x16x32_bf16 v[12:15], a[12:15], v[80:83], v[12:15]
ds_read_b64_tr_b16 v[64:65], v110 offset:0
ds_read_b64_tr_b16 v[66:67], v110 offset:1024
s_add_u32 m0, s74, 0
s_nop 0
buffer_load_dwordx4 v92, s[40:43], s99 offen offset:0  lds
v_mfma_f32_16x16x32_bf16 v[16:19], a[76:79], v[80:83], v[16:19]
ds_read_b64_tr_b16 v[68:69], v111 offset:0
ds_read_b64_tr_b16 v[70:71], v111 offset:1024
v_mfma_f32_16x16x32_bf16 v[20:23], a[12:15], v[84:87], v[20:23]
ds_read_b64_tr_b16 v[72:73], v112 offset:0
ds_read_b64_tr_b16 v[74:75], v112 offset:1024
v_mfma_f32_16x16x32_bf16 v[24:27], a[76:79], v[84:87], v[24:27]
v_mfma_f32_16x16x32_bf16 v[28:31], a[12:15], v[88:91], v[28:31]
buffer_load_dwordx4 v93, s[40:43], s99 offen offset:1024  lds
s_add_u32 s99, s99, 128
s_cmp_eq_u32 s99, 1024
s_cselect_b32 s99, 0, s99
v_mfma_f32_16x16x32_bf16 v[32:35], a[76:79], v[88:91], v[32:35]
s_waitcnt lgkmcnt(0)
v_mfma_f32_16x16x32_bf16 v[4:7], a[16:19], v[60:63], v[4:7]
ds_read_b128 a[20:23], v114 offset:0
ds_read_b128 a[84:87], v114 offset:2048
v_mfma_f32_16x16x32_bf16 v[8:11], a[80:83], v[60:63], v[8:11]
ds_read_b64_tr_b16 v[76:77], v109 offset:8192
ds_read_b64_tr_b16 v[78:79], v109 offset:9216
v_mfma_f32_16x16x32_bf16 v[12:15], a[16:19], v[64:67], v[12:15]
ds_read_b64_tr_b16 v[80:81], v110 offset:8192
ds_read_b64_tr_b16 v[82:83], v110 offset:9216
s_add_u32 m0, s74, 16384
s_nop 0
buffer_load_dwordx4 v94, s[44:47], s100 offen offset:0  lds
v_mfma_f32_16x16x32_bf16 v[16:19], a[80:83], v[64:67], v[16:19]
ds_read_b64_tr_b16 v[84:85], v111 offset:8192
ds_read_b64_tr_b16 v[86:87], v111 offset:9216
v_mfma_f32_16x16x32_bf16 v[20:23], a[16:19], v[68:71], v[20:23]
ds_read_b64_tr_b16 v[88:89], v112 offset:8192
ds_read_b64_tr_b16 v[90:91], v112 offset:9216
v_mfma_f32_16x16x32_bf16 v[24:27], a[80:83], v[68:71], v[24:27]
v_mfma_f32_16x16x32_bf16 v[28:31], a[16:19], v[72:75], v[28:31]
buffer_load_dwordx4 v95, s[44:47], s100 offen offset:1024  lds
s_add_u32 s100, s100, 196608
s_cmp_eq_u32 s100, 1572864
s_cselect_b32 s100, 0, s100
v_mfma_f32_16x16x32_bf16 v[32:35], a[80:83], v[72:75], v[32:35]
s_waitcnt lgkmcnt(0)
s_waitcnt vmcnt(4)
s_barrier
v_add_u32 v109, 114688, v102
v_add_u32 v110, 114688, v103
v_add_u32 v111, 114688, v104
v_add_u32 v112, 114688, v105
v_add_u32 v113, 98304, v100
v_add_u32 v114, 98304, v101
v_mfma_f32_16x16x32_bf16 v[4:7], a[20:23], v[76:79], v[4:7]
ds_read_b128 a[24:27], v113 offset:0
ds_read_b128 a[88:91], v113 offset:2048
v_mfma_f32_16x16x32_bf16 v[8:11], a[84:87], v[76:79], v[8:11]
ds_read_b64_tr_b16 v[60:61], v109 offset:0
ds_read_b64_tr_b16 v[62:63], v109 offset:1024
v_mfma_f32_16x16x32_bf16 v[12:15], a[20:23], v[80:83], v[12:15]
ds_read_b64_tr_b16 v[64:65], v110 offset:0
ds_read_b64_tr_b16 v[66:67], v110 offset:1024
s_add_u32 m0, s74, 32768
s_nop 0
buffer_load_dwordx4 v92, s[40:43], s99 offen offset:0  lds
v_mfma_f32_16x16x32_bf16 v[16:19], a[84:87], v[80:83], v[16:19]
ds_read_b64_tr_b16 v[68:69], v111 offset:0
ds_read_b64_tr_b16 v[70:71], v111 offset:1024
v_mfma_f32_16x16x32_bf16 v[20:23], a[20:23], v[84:87], v[20:23]
ds_read_b64_tr_b16 v[72:73], v112 offset:0
ds_read_b64_tr_b16 v[74:75], v112 offset:1024
v_mfma_f32_16x16x32_bf16 v[24:27], a[84:87], v[84:87], v[24:27]
v_mfma_f32_16x16x32_bf16 v[28:31], a[20:23], v[88:91], v[28:31]
buffer_load_dwordx4 v93, s[40:43], s99 offen offset:1024  lds
s_add_u32 s99, s99, 128
s_cmp_eq_u32 s99, 1024
s_cselect_b32 s99, 0, s99
v_mfma_f32_16x16x32_bf16 v[32:35], a[84:87], v[88:91], v[32:35]
s_waitcnt lgkmcnt(0)
v_mfma_f32_16x16x32_bf16 v[4:7], a[24:27], v[60:63], v[4:7]
ds_read_b128 a[28:31], v114 offset:0
ds_read_b128 a[92:95], v114 offset:2048
v_mfma_f32_16x16x32_bf16 v[8:11], a[88:91], v[60:63], v[8:11]
ds_read_b64_tr_b16 v[76:77], v109 offset:8192
ds_read_b64_tr_b16 v[78:79], v109 offset:9216
v_mfma_f32_16x16x32_bf16 v[12:15], a[24:27], v[64:67], v[12:15]
ds_read_b64_tr_b16 v[80:81], v110 offset:8192
ds_read_b64_tr_b16 v[82:83], v110 offset:9216
s_add_u32 m0, s74, 49152
s_nop 0
buffer_load_dwordx4 v94, s[44:47], s100 offen offset:0  lds
v_mfma_f32_16x16x32_bf16 v[16:19], a[88:91], v[64:67], v[16:19]
ds_read_b64_tr_b16 v[84:85], v111 offset:8192
ds_read_b64_tr_b16 v[86:87], v111 offset:9216
v_mfma_f32_16x16x32_bf16 v[20:23], a[24:27], v[68:71], v[20:23]
ds_read_b64_tr_b16 v[88:89], v112 offset:8192
ds_read_b64_tr_b16 v[90:91], v112 offset:9216
v_mfma_f32_16x16x32_bf16 v[24:27], a[88:91], v[68:71], v[24:27]
v_mfma_f32_16x16x32_bf16 v[28:31], a[24:27], v[72:75], v[28:31]
buffer_load_dwordx4 v95, s[44:47], s100 offen offset:1024  lds
s_add_u32 s100, s100, 196608
s_cmp_eq_u32 s100, 1572864
s_cselect_b32 s100, 0, s100
v_mfma_f32_16x16x32_bf16 v[32:35], a[88:91], v[72:75], v[32:35]
s_waitcnt lgkmcnt(0)
s_waitcnt vmcnt(4)
s_barrier
s_cmp_lg_u32 s2, 0
s_cbranch_scc1 init_7
s_cmp_lg_u32 s6, 0
s_cbranch_scc1 init_7
s_memrealtime s[62:63]
s_waitcnt lgkmcnt(0)
s_or_b32 s62, s62, 1
v_mov_b32 v2, 0
v_mov_b32 v3, s62
s_mov_b64 exec, 1
buffer_store_dword v3, v2, s[92:95], 0 offen sc1
s_mov_b64 exec, -1
init_7:
v_mfma_f32_16x16x32_bf16 v[4:7], a[28:31], v[76:79], v[4:7]
ds_read_b128 a[32:35], v100 offset:0
ds_read_b128 a[96:99], v100 offset:2048
v_mfma_f32_16x16x32_bf16 v[8:11], a[92:95], v[76:79], v[8:11]
ds_read_b64_tr_b16 v[60:61], v102 offset:16384
ds_read_b64_tr_b16 v[62:63], v102 offset:17408
v_mfma_f32_16x16x32_bf16 v[12:15], a[28:31], v[80:83], v[12:15]
ds_read_b64_tr_b16 v[64:65], v103 offset:16384
ds_read_b64_tr_b16 v[66:67], v103 offset:17408
s_add_u32 m0, s74, 65536
s_nop 0
buffer_load_dwordx4 v92, s[40:43], s99 offen offset:0  lds
v_mfma_f32_16x16x32_bf16 v[16:19], a[92:95], v[80:83], v[16:19]
ds_read_b64_tr_b16 v[68:69], v104 offset:16384
ds_read_b64_tr_b16 v[70:71], v104 offset:17408
v_mfma_f32_16x16x32_bf16 v[20:23], a[28:31], v[84:87], v[20:23]
ds_read_b64_tr_b16 v[72:73], v105 offset:16384
ds_read_b64_tr_b16 v[74:75], v105 offset:17408
v_mfma_f32_16x16x32_bf16 v[24:27], a[92:95], v[84:87], v[24:27]
v_mfma_f32_16x16x32_bf16 v[28:31], a[28:31], v[88:91], v[28:31]
buffer_load_dwordx4 v93, s[40:43], s99 offen offset:1024  lds
s_add_u32 s99, s99, 128
s_cmp_eq_u32 s99, 1024
s_cselect_b32 s99, 0, s99
v_mfma_f32_16x16x32_bf16 v[32:35], a[92:95], v[88:91], v[32:35]
s_waitcnt lgkmcnt(0)
v_mfma_f32_16x16x32_bf16 v[4:7], a[32:35], v[60:63], v[4:7]
ds_read_b128 a[36:39], v101 offset:0
ds_read_b128 a[100:103], v101 offset:2048
v_mfma_f32_16x16x32_bf16 v[8:11], a[96:99], v[60:63], v[8:11]
ds_read_b64_tr_b16 v[76:77], v102 offset:24576
ds_read_b64_tr_b16 v[78:79], v102 offset:25600
v_mfma_f32_16x16x32_bf16 v[12:15], a[32:35], v[64:67], v[12:15]
ds_read_b64_tr_b16 v[80:81], v103 offset:24576
ds_read_b64_tr_b16 v[82:83], v103 offset:25600
s_add_u32 m0, s74, 81920
s_nop 0
buffer_load_dwordx4 v94, s[44:47], s100 offen offset:0  lds
v_mfma_f32_16x16x32_bf16 v[16:19], a[96:99], v[64:67], v[16:19]
ds_read_b64_tr_b16 v[84:85], v104 offset:24576
ds_read_b64_tr_b16 v[86:87], v104 offset:25600
v_mfma_f32_16x16x32_bf16 v[20:23], a[32:35], v[68:71], v[20:23]
ds_read_b64_tr_b16 v[88:89], v105 offset:24576
ds_read_b64_tr_b16 v[90:91], v105 offset:25600
v_mfma_f32_16x16x32_bf16 v[24:27], a[96:99], v[68:71], v[24:27]
v_mfma_f32_16x16x32_bf16 v[28:31], a[32:35], v[72:75], v[28:31]
buffer_load_dwordx4 v95, s[44:47], s100 offen offset:1024  lds
s_add_u32 s100, s100, 196608
s_cmp_eq_u32 s100, 1572864
s_cselect_b32 s100, 0, s100
v_mfma_f32_16x16x32_bf16 v[32:35], a[96:99], v[72:75], v[32:35]
s_waitcnt lgkmcnt(0)
s_waitcnt vmcnt(4)
s_barrier
v_mfma_f32_16x16x32_bf16 v[4:7], a[36:39], v[76:79], v[4:7]
ds_read_b128 a[40:43], v100 offset:32768
ds_read_b128 a[104:107], v100 offset:34816
v_mfma_f32_16x16x32_bf16 v[8:11], a[100:103], v[76:79], v[8:11]
ds_read_b64_tr_b16 v[60:61], v102 offset:49152
ds_read_b64_tr_b16 v[62:63], v102 offset:50176
v_mfma_f32_16x16x32_bf16 v[12:15], a[36:39], v[80:83], v[12:15]
ds_read_b64_tr_b16 v[64:65], v103 offset:49152
ds_read_b64_tr_b16 v[66:67], v103 offset:50176
s_add_u32 m0, s74, 98304
s_nop 0
buffer_load_dwordx4 v92, s[40:43], s99 offen offset:0  lds
v_mfma_f32_16x16x32_bf16 v[16:19], a[100:103], v[80:83], v[16:19]
ds_read_b64_tr_b16 v[68:69], v104 offset:49152
ds_read_b64_tr_b16 v[70:71], v104 offset:50176
v_mfma_f32_16x16x32_bf16 v[20:23], a[36:39], v[84:87], v[20:23]
ds_read_b64_tr_b16 v[72:73], v105 offset:49152
ds_read_b64_tr_b16 v[74:75], v105 offset:50176
v_mfma_f32_16x16x32_bf16 v[24:27], a[100:103], v[84:87], v[24:27]
v_mfma_f32_16x16x32_bf16 v[28:31], a[36:39], v[88:91], v[28:31]
buffer_load_dwordx4 v93, s[40:43], s99 offen offset:1024  lds
s_add_u32 s99, s99, 128
s_cmp_eq_u32 s99, 1024
s_cselect_b32 s99, 0, s99
v_mfma_f32_16x16x32_bf16 v[32:35], a[100:103], v[88:91], v[32:35]
s_waitcnt lgkmcnt(0)
v_mfma_f32_16x16x32_bf16 v[4:7], a[40:43], v[60:63], v[4:7]
ds_read_b128 a[44:47], v101 offset:32768
ds_read_b128 a[108:111], v101 offset:34816
v_mfma_f32_16x16x32_bf16 v[8:11], a[104:107], v[60:63], v[8:11]
ds_read_b64_tr_b16 v[76:77], v102 offset:57344
ds_read_b64_tr_b16 v[78:79], v102 offset:58368
v_mfma_f32_16x16x32_bf16 v[12:15], a[40:43], v[64:67], v[12:15]
ds_read_b64_tr_b16 v[80:81], v103 offset:57344
ds_read_b64_tr_b16 v[82:83], v103 offset:58368
s_add_u32 m0, s74, 114688
s_nop 0
buffer_load_dwordx4 v94, s[44:47], s100 offen offset:0  lds
v_mfma_f32_16x16x32_bf16 v[16:19], a[104:107], v[64:67], v[16:19]
ds_read_b64_tr_b16 v[84:85], v104 offset:57344
ds_read_b64_tr_b16 v[86:87], v104 offset:58368
v_mfma_f32_16x16x32_bf16 v[20:23], a[40:43], v[68:71], v[20:23]
ds_read_b64_tr_b16 v[88:89], v105 offset:57344
ds_read_b64_tr_b16 v[90:91], v105 offset:58368
v_mfma_f32_16x16x32_bf16 v[24:27], a[104:107], v[68:71], v[24:27]
v_mfma_f32_16x16x32_bf16 v[28:31], a[40:43], v[72:75], v[28:31]
buffer_load_dwordx4 v95, s[44:47], s100 offen offset:1024  lds
s_add_u32 s100, s100, 196608
s_cmp_eq_u32 s100, 1572864
s_cselect_b32 s100, 0, s100
v_mfma_f32_16x16x32_bf16 v[32:35], a[104:107], v[72:75], v[32:35]
s_waitcnt lgkmcnt(0)
s_waitcnt vmcnt(4)
s_barrier
v_add_u32 v109, 81920, v102
v_add_u32 v110, 81920, v103
v_add_u32 v111, 81920, v104
v_add_u32 v112, 81920, v105
v_add_u32 v113, 65536, v100
v_add_u32 v114, 65536, v101
v_mfma_f32_16x16x32_bf16 v[4:7], a[44:47], v[76:79], v[4:7]
ds_read_b128 a[48:51], v113 offset:0
ds_read_b128 a[112:115], v113 offset:2048
v_mfma_f32_16x16x32_bf16 v[8:11], a[108:111], v[76:79], v[8:11]
ds_read_b64_tr_b16 v[60:61], v109 offset:0
ds_read_b64_tr_b16 v[62:63], v109 offset:1024
v_mfma_f32_16x16x32_bf16 v[12:15], a[44:47], v[80:83], v[12:15]
ds_read_b64_tr_b16 v[64:65], v110 offset:0
ds_read_b64_tr_b16 v[66:67], v110 offset:1024
v_mfma_f32_16x16x32_bf16 v[16:19], a[108:111], v[80:83], v[16:19]
ds_read_b64_tr_b16 v[68:69], v111 offset:0
ds_read_b64_tr_b16 v[70:71], v111 offset:1024
v_mfma_f32_16x16x32_bf16 v[20:23], a[44:47], v[84:87], v[20:23]
ds_read_b64_tr_b16 v[72:73], v112 offset:0
ds_read_b64_tr_b16 v[74:75], v112 offset:1024
v_mfma_f32_16x16x32_bf16 v[24:27], a[108:111], v[84:87], v[24:27]
v_mfma_f32_16x16x32_bf16 v[28:31], a[44:47], v[88:91], v[28:31]
v_mfma_f32_16x16x32_bf16 v[32:35], a[108:111], v[88:91], v[32:35]
s_waitcnt lgkmcnt(0)
v_mfma_f32_16x16x32_bf16 v[4:7], a[48:51], v[60:63], v[4:7]
ds_read_b128 a[52:55], v114 offset:0
ds_read_b128 a[116:119], v114 offset:2048
v_mfma_f32_16x16x32_bf16 v[8:11], a[112:115], v[60:63], v[8:11]
ds_read_b64_tr_b16 v[76:77], v109 offset:8192
ds_read_b64_tr_b16 v[78:79], v109 offset:9216
v_mfma_f32_16x16x32_bf16 v[12:15], a[48:51], v[64:67], v[12:15]
ds_read_b64_tr_b16 v[80:81], v110 offset:8192
ds_read_b64_tr_b16 v[82:83], v110 offset:9216
v_mfma_f32_16x16x32_bf16 v[16:19], a[112:115], v[64:67], v[16:19]
ds_read_b64_tr_b16 v[84:85], v111 offset:8192
ds_read_b64_tr_b16 v[86:87], v111 offset:9216
v_mfma_f32_16x16x32_bf16 v[20:23], a[48:51], v[68:71], v[20:23]
ds_read_b64_tr_b16 v[88:89], v112 offset:8192
ds_read_b64_tr_b16 v[90:91], v112 offset:9216
v_mfma_f32_16x16x32_bf16 v[24:27], a[112:115], v[68:71], v[24:27]
v_mfma_f32_16x16x32_bf16 v[28:31], a[48:51], v[72:75], v[28:31]
v_mfma_f32_16x16x32_bf16 v[32:35], a[112:115], v[72:75], v[32:35]
s_waitcnt lgkmcnt(0)
s_waitcnt vmcnt(0)
s_barrier
v_add_u32 v109, 114688, v102
v_add_u32 v110, 114688, v103
v_add_u32 v111, 114688, v104
v_add_u32 v112, 114688, v105
v_add_u32 v113, 98304, v100
v_add_u32 v114, 98304, v101
v_mfma_f32_16x16x32_bf16 v[4:7], a[52:55], v[76:79], v[4:7]
ds_read_b128 a[56:59], v113 offset:0
ds_read_b128 a[120:123], v113 offset:2048
v_mfma_f32_16x16x32_bf16 v[8:11], a[116:119], v[76:79], v[8:11]
ds_read_b64_tr_b16 v[60:61], v109 offset:0
ds_read_b64_tr_b16 v[62:63], v109 offset:1024
v_mfma_f32_16x16x32_bf16 v[12:15], a[52:55], v[80:83], v[12:15]
ds_read_b64_tr_b16 v[64:65], v110 offset:0
ds_read_b64_tr_b16 v[66:67], v110 offset:1024
v_mfma_f32_16x16x32_bf16 v[16:19], a[116:119], v[80:83], v[16:19]
ds_read_b64_tr_b16 v[68:69], v111 offset:0
ds_read_b64_tr_b16 v[70:71], v111 offset:1024
v_mfma_f32_16x16x32_bf16 v[20:23], a[52:55], v[84:87], v[20:23]
ds_read_b64_tr_b16 v[72:73], v112 offset:0
ds_read_b64_tr_b16 v[74:75], v112 offset:1024
v_mfma_f32_16x16x32_bf16 v[24:27], a[116:119], v[84:87], v[24:27]
v_mfma_f32_16x16x32_bf16 v[28:31], a[52:55], v[88:91], v[28:31]
v_mfma_f32_16x16x32_bf16 v[32:35], a[116:119], v[88:91], v[32:35]
s_waitcnt lgkmcnt(0)
v_mfma_f32_16x16x32_bf16 v[4:7], a[56:59], v[60:63], v[4:7]
ds_read_b128 a[60:63], v114 offset:0
ds_read_b128 a[124:127], v114 offset:2048
v_mfma_f32_16x16x32_bf16 v[8:11], a[120:123], v[60:63], v[8:11]
ds_read_b64_tr_b16 v[76:77], v109 offset:8192
ds_read_b64_tr_b16 v[78:79], v109 offset:9216
v_mfma_f32_16x16x32_bf16 v[12:15], a[56:59], v[64:67], v[12:15]
ds_read_b64_tr_b16 v[80:81], v110 offset:8192
ds_read_b64_tr_b16 v[82:83], v110 offset:9216
v_mfma_f32_16x16x32_bf16 v[16:19], a[120:123], v[64:67], v[16:19]
ds_read_b64_tr_b16 v[84:85], v111 offset:8192
ds_read_b64_tr_b16 v[86:87], v111 offset:9216
v_mfma_f32_16x16x32_bf16 v[20:23], a[56:59], v[68:71], v[20:23]
ds_read_b64_tr_b16 v[88:89], v112 offset:8192
ds_read_b64_tr_b16 v[90:91], v112 offset:9216
v_mfma_f32_16x16x32_bf16 v[24:27], a[120:123], v[68:71], v[24:27]
v_mfma_f32_16x16x32_bf16 v[28:31], a[56:59], v[72:75], v[28:31]
v_mfma_f32_16x16x32_bf16 v[32:35], a[120:123], v[72:75], v[32:35]
s_waitcnt lgkmcnt(0)
v_mfma_f32_16x16x32_bf16 v[4:7], a[60:63], v[76:79], v[4:7]
v_mfma_f32_16x16x32_bf16 v[8:11], a[124:127], v[76:79], v[8:11]
v_mfma_f32_16x16x32_bf16 v[12:15], a[60:63], v[80:83], v[12:15]
v_mfma_f32_16x16x32_bf16 v[16:19], a[124:127], v[80:83], v[16:19]
v_mfma_f32_16x16x32_bf16 v[20:23], a[60:63], v[84:87], v[20:23]
v_mfma_f32_16x16x32_bf16 v[24:27], a[124:127], v[84:87], v[24:27]
v_mfma_f32_16x16x32_bf16 v[28:31], a[60:63], v[88:91], v[28:31]
v_mfma_f32_16x16x32_bf16 v[32:35], a[124:127], v[88:91], v[32:35]
s_mov_b32 s76, 0x3fb8aa3b
s_mov_b32 s77, 0x3fb8aa3b
s_mov_b32 s78, 0x358637bd
s_mov_b32 s79, 0x358637bd
v_pk_mul_f32 v[60:61], v[4:5], s[76:77]
v_pk_mul_f32 v[62:63], v[6:7], s[76:77]
v_pk_mul_f32 v[64:65], v[8:9], s[76:77]
v_pk_mul_f32 v[66:67], v[10:11], s[76:77]
s_add_u32 m0, s75, 0
s_nop 0
buffer_load_dwordx4 v96, s[44:47], s101 offen offset:0  lds
s_add_u32 s101, s101, 196608
s_cmp_eq_u32 s101, 1572864
s_cselect_b32 s101, 0, s101
v_exp_f32 v60, v60 clamp
v_exp_f32 v61, v61 clamp
v_exp_f32 v62, v62 clamp
v_exp_f32 v63, v63 clamp
s_add_u32 m0, s75, 16384
s_nop 0
buffer_load_dwordx4 v96, s[44:47], s101 offen offset:0  lds
s_add_u32 s101, s101, 196608
s_cmp_eq_u32 s101, 1572864
s_cselect_b32 s101, 0, s101
v_exp_f32 v64, v64 clamp
v_exp_f32 v65, v65 clamp
v_exp_f32 v66, v66 clamp
v_exp_f32 v67, v67 clamp
s_add_u32 m0, s75, 32768
s_nop 0
buffer_load_dwordx4 v96, s[44:47], s101 offen offset:0  lds
s_add_u32 s101, s101, 196608
s_cmp_eq_u32 s101, 1572864
s_cselect_b32 s101, 0, s101
v_max_f32 v4, 0, v4
v_max_f32 v5, 0, v5
v_max_f32 v6, 0, v6
v_max_f32 v7, 0, v7
s_add_u32 m0, s75, 49152
s_nop 0
buffer_load_dwordx4 v96, s[44:47], s101 offen offset:0  lds
s_add_u32 s101, s101, 196608
s_cmp_eq_u32 s101, 1572864
s_cselect_b32 s101, 0, s101
v_max_f32 v8, 0, v8
v_max_f32 v9, 0, v9
v_max_f32 v10, 0, v10
v_max_f32 v11, 0, v11
s_add_u32 m0, s75, 65536
s_nop 0
buffer_load_dwordx4 v96, s[44:47], s101 offen offset:0  lds
s_add_u32 s101, s101, 196608
s_cmp_eq_u32 s101, 1572864
s_cselect_b32 s101, 0, s101
v_pk_add_f32 v[60:61], v[60:61], s[78:79]
v_pk_add_f32 v[62:63], v[62:63], s[78:79]
v_pk_add_f32 v[64:65], v[64:65], s[78:79]
v_pk_add_f32 v[66:67], v[66:67], s[78:79]
s_add_u32 m0, s75, 81920
s_nop 0
buffer_load_dwordx4 v96, s[44:47], s101 offen offset:0  lds
s_add_u32 s101, s101, 196608
s_cmp_eq_u32 s101, 1572864
s_cselect_b32 s101, 0, s101
v_pk_add_f32 v[4:5], v[4:5], v[60:61]
v_pk_add_f32 v[6:7], v[6:7], v[62:63]
v_pk_add_f32 v[8:9], v[8:9], v[64:65]
v_pk_add_f32 v[10:11], v[10:11], v[66:67]
v_pk_mul_f32 v[60:61], v[12:13], s[76:77]
v_pk_mul_f32 v[62:63], v[14:15], s[76:77]
v_pk_mul_f32 v[64:65], v[16:17], s[76:77]
v_pk_mul_f32 v[66:67], v[18:19], s[76:77]
v_exp_f32 v60, v60 clamp
v_exp_f32 v61, v61 clamp
v_exp_f32 v62, v62 clamp
v_exp_f32 v63, v63 clamp
v_exp_f32 v64, v64 clamp
v_exp_f32 v65, v65 clamp
v_exp_f32 v66, v66 clamp
v_exp_f32 v67, v67 clamp
v_max_f32 v12, 0, v12
v_max_f32 v13, 0, v13
v_max_f32 v14, 0, v14
v_max_f32 v15, 0, v15
v_max_f32 v16, 0, v16
v_max_f32 v17, 0, v17
v_max_f32 v18, 0, v18
v_max_f32 v19, 0, v19
v_pk_add_f32 v[60:61], v[60:61], s[78:79]
v_pk_add_f32 v[62:63], v[62:63], s[78:79]
v_pk_add_f32 v[64:65], v[64:65], s[78:79]
v_pk_add_f32 v[66:67], v[66:67], s[78:79]
v_pk_add_f32 v[12:13], v[12:13], v[60:61]
v_pk_add_f32 v[14:15], v[14:15], v[62:63]
v_pk_add_f32 v[16:17], v[16:17], v[64:65]
v_pk_add_f32 v[18:19], v[18:19], v[66:67]
v_cvt_pk_bf16_f32 v68, v4, v5
v_cvt_pk_bf16_f32 v69, v6, v7
v_cvt_pk_bf16_f32 v76, v20, v21
v_cvt_pk_bf16_f32 v77, v22, v23
v_cvt_pk_bf16_f32 v70, v8, v9
v_cvt_pk_bf16_f32 v71, v10, v11
v_cvt_pk_bf16_f32 v78, v24, v25
v_cvt_pk_bf16_f32 v79, v26, v27
v_cvt_pk_bf16_f32 v72, v12, v13
v_cvt_pk_bf16_f32 v73, v14, v15
v_cvt_pk_bf16_f32 v80, v28, v29
v_cvt_pk_bf16_f32 v81, v30, v31
v_cvt_pk_bf16_f32 v74, v16, v17
v_cvt_pk_bf16_f32 v75, v18, v19
v_cvt_pk_bf16_f32 v82, v32, v33
v_cvt_pk_bf16_f32 v83, v34, v35
v_mov_b32 v84, 0x3f803f80
v_mov_b32 v85, 0x3f803f80
v_mov_b32 v86, 0x3f803f80
v_mov_b32 v87, 0x3f803f80
v_mfma_f32_16x16x32_bf16 v[36:39], v[68:71], v[76:79], 0
s_nop 0
v_mfma_f32_16x16x32_bf16 v[40:43], v[68:71], v[84:87], 0
v_mfma_f32_16x16x32_bf16 v[44:47], v[72:75], v[80:83], 0
v_mfma_f32_16x16x32_bf16 v[48:51], v[72:75], v[84:87], 0
s_lshl_b32 s60, s8, 13
s_lshl_b32 s61, s7, 10
s_add_u32 s60, s60, s61
s_add_u32 s60, s60, 131072
v_lshlrev_b32 v115, 4, v0
v_add_u32 v116, s60, v115
ds_write_b128 v116, v[36:39] offset:0
ds_write_b128 v116, v[40:43] offset:16384
ds_write_b128 v116, v[44:47] offset:4096
ds_write_b128 v116, v[48:51] offset:20480
s_waitcnt lgkmcnt(0)
v_lshrrev_b32 v117, 4, v0
v_and_b32 v118, 15, v0
s_and_b32 s60, s6, 1
s_lshl_b32 s60, s60, 3
v_xor_b32 v119, v118, v117
v_xor_b32 v119, s60, v119
v_lshlrev_b32 v119, 4, v119
v_lshl_add_u32 v119, v117, 12, v119
s_lshl_b32 s60, s96, 18
s_lshl_b32 s61, s6, 15
s_add_u32 s60, s60, s61
v_add_u32 v98, s60, v119
v_xor_b32 v99, 64, v98
v_add_u32 v99, 15360, v99
s_waitcnt vmcnt(4)
s_barrier
s_lshl_b32 s60, s7, 12
s_lshl_b32 s61, s8, 14
s_add_u32 s60, s60, s61
s_add_u32 s60, s60, 131072
v_lshlrev_b32 v115, 4, v0
v_add_u32 v116, s60, v115
ds_read_b128 v[4:7], v116 offset:0
ds_read_b128 v[8:11], v116 offset:1024
ds_read_b128 v[12:15], v116 offset:2048
ds_read_b128 v[16:19], v116 offset:3072
s_lshl_b32 s60, s9, 5
s_lshl_b32 s62, s10, 2
s_add_u32 s60, s60, s62
s_add_u32 s60, s60, s7
s_waitcnt lgkmcnt(0)
v_pk_add_f32 v[4:5], v[4:5], v[8:9]
v_pk_add_f32 v[12:13], v[12:13], v[16:17]
v_pk_add_f32 v[6:7], v[6:7], v[10:11]
v_pk_add_f32 v[14:15], v[14:15], v[18:19]
v_pk_add_f32 v[4:5], v[4:5], v[12:13]
v_pk_add_f32 v[6:7], v[6:7], v[14:15]
s_cmp_lg_u32 s8, 0
s_cbranch_scc1 kz_8
s_lshl_b32 s60, s60, 10
s_add_u32 s60, s60, 14680064
buffer_store_dwordx4 v[4:7], v115, s[48:51], s60 offen offset:0 sc1
s_branch kzj_9
kz_8:
s_lshl_b32 s60, s60, 6
s_add_u32 s60, s60, 15204352
v_and_b32 v117, 0x30, v0
s_mov_b64 s[68:69], exec
s_mov_b32 exec_lo, 0x00010001
s_mov_b32 exec_hi, 0x00010001
buffer_store_dwordx4 v[4:7], v117, s[48:51], s60 offen offset:0 sc1
s_mov_b64 exec, s[68:69]
kzj_9:
s_cmp_lg_u32 s6, 0
s_cbranch_scc1 if_10
v_mov_b32 v126, 0
buffer_load_dword v126, v126, s[92:95], 0 offen sc1
if_10:
ds_read_b64_tr_b16 v[60:61], v106 offset:0
ds_read_b64_tr_b16 v[62:63], v106 offset:512
ds_read_b64_tr_b16 v[64:65], v107 offset:0
ds_read_b64_tr_b16 v[66:67], v107 offset:512
s_add_u32 m0, s75, 98304
s_nop 0
buffer_load_dwordx4 v96, s[44:47], s101 offen offset:0  lds
s_add_u32 s101, s101, 196608
s_cmp_eq_u32 s101, 1572864
s_cselect_b32 s101, 0, s101
s_waitcnt lgkmcnt(0)
v_mfma_f32_16x16x32_bf16 v[36:39], v[60:63], a[0:3], 0
ds_read_b64_tr_b16 v[76:77], v106 offset:4096
ds_read_b64_tr_b16 v[78:79], v106 offset:4608
v_mfma_f32_16x16x32_bf16 v[40:43], v[60:63], a[64:67], 0
ds_read_b64_tr_b16 v[80:81], v107 offset:4096
ds_read_b64_tr_b16 v[82:83], v107 offset:4608
v_mfma_f32_16x16x32_bf16 v[44:47], v[64:67], a[0:3], 0
s_add_u32 m0, s75, 114688
s_nop 0
buffer_load_dwordx4 v96, s[44:47], s101 offen offset:0  lds
s_add_u32 s101, s101, 196608
s_cmp_eq_u32 s101, 1572864
s_cselect_b32 s101, 0, s101
v_mfma_f32_16x16x32_bf16 v[48:51], v[64:67], a[64:67], 0
s_waitcnt lgkmcnt(0)
v_mfma_f32_16x16x32_bf16 v[36:39], v[76:79], a[4:7], v[36:39]
ds_read_b64_tr_b16 v[60:61], v106 offset:16384
ds_read_b64_tr_b16 v[62:63], v106 offset:16896
v_mfma_f32_16x16x32_bf16 v[40:43], v[76:79], a[68:71], v[40:43]
ds_read_b64_tr_b16 v[64:65], v107 offset:16384
ds_read_b64_tr_b16 v[66:67], v107 offset:16896
v_mfma_f32_16x16x32_bf16 v[44:47], v[80:83], a[4:7], v[44:47]
v_mfma_f32_16x16x32_bf16 v[48:51], v[80:83], a[68:71], v[48:51]
s_waitcnt lgkmcnt(0)
v_mfma_f32_16x16x32_bf16 v[36:39], v[60:63], a[8:11], v[36:39]
ds_read_b64_tr_b16 v[76:77], v106 offset:20480
ds_read_b64_tr_b16 v[78:79], v106 offset:20992
v_mfma_f32_16x16x32_bf16 v[40:43], v[60:63], a[72:75], v[40:43]
ds_read_b64_tr_b16 v[80:81], v107 offset:20480
ds_read_b64_tr_b16 v[82:83], v107 offset:20992
v_mfma_f32_16x16x32_bf16 v[44:47], v[64:67], a[8:11], v[44:47]
v_mfma_f32_16x16x32_bf16 v[48:51], v[64:67], a[72:75], v[48:51]
s_waitcnt lgkmcnt(0)
s_waitcnt vmcnt(2)
s_barrier
s_cmp_lg_u32 s6, 0
s_cbranch_scc1 if_11
v_readfirstlane_b32 s64, v126
s_nop 3
s_cmp_lg_u32 s64, 0
s_cbranch_scc1 fl_12
v_mov_b32 v123, 0
s_mov_b32 s65, 0
flp_13:
buffer_load_dword v122, v123, s[92:95], 0 offen sc1
s_waitcnt vmcnt(0)
v_readfirstlane_b32 s64, v122
s_add_u32 s65, s65, 1
s_nop 2
s_cmp_ge_u32 s64, 1
s_cbranch_scc1 flpok_14
s_cmp_lt_u32 s65, 100000
s_cbranch_scc0 flpok_14
s_sleep 1
s_branch flp_13
flpok_14:
fl_12:
if_11:
v_mfma_f32_16x16x32_bf16 v[36:39], v[76:79], a[12:15], v[36:39]
ds_read_b64_tr_b16 v[60:61], v106 offset:32768
ds_read_b64_tr_b16 v[62:63], v106 offset:33280
v_mfma_f32_16x16x32_bf16 v[40:43], v[76:79], a[76:79], v[40:43]
ds_read_b64_tr_b16 v[64:65], v107 offset:32768
ds_read_b64_tr_b16 v[66:67], v107 offset:33280
s_add_u32 m0, s74, 0
s_add_u32 s3, s5, 0
s_and_b32 s3, s3, 3
s_lshl_b32 s3, s3, 8
buffer_load_dwordx4 v98, s[52:55], s3 offen offset:0  lds
v_mfma_f32_16x16x32_bf16 v[44:47], v[80:83], a[12:15], v[44:47]
v_mfma_f32_16x16x32_bf16 v[48:51], v[80:83], a[76:79], v[48:51]
buffer_load_dwordx4 v99, s[52:55], s3 offen offset:1024  lds
s_waitcnt lgkmcnt(0)
v_mfma_f32_16x16x32_bf16 v[36:39], v[60:63], a[16:19], v[36:39]
ds_read_b64_tr_b16 v[76:77], v106 offset:36864
ds_read_b64_tr_b16 v[78:79], v106 offset:37376
v_mfma_f32_16x16x32_bf16 v[40:43], v[60:63], a[80:83], v[40:43]
ds_read_b64_tr_b16 v[80:81], v107 offset:36864
ds_read_b64_tr_b16 v[82:83], v107 offset:37376
s_add_u32 m0, s74, 16384
s_add_u32 s3, s5, 0
s_and_b32 s3, s3, 3
s_lshl_b32 s3, s3, 8
s_add_u32 s3, s3, 1024
buffer_load_dwordx4 v98, s[52:55], s3 offen offset:0  lds
v_mfma_f32_16x16x32_bf16 v[44:47], v[64:67], a[16:19], v[44:47]
v_mfma_f32_16x16x32_bf16 v[48:51], v[64:67], a[80:83], v[48:51]
buffer_load_dwordx4 v99, s[52:55], s3 offen offset:1024  lds
s_waitcnt lgkmcnt(0)
v_mfma_f32_16x16x32_bf16 v[36:39], v[76:79], a[20:23], v[36:39]
ds_read_b64_tr_b16 v[60:61], v106 offset:49152
ds_read_b64_tr_b16 v[62:63], v106 offset:49664
v_mfma_f32_16x16x32_bf16 v[40:43], v[76:79], a[84:87], v[40:43]
ds_read_b64_tr_b16 v[64:65], v107 offset:49152
ds_read_b64_tr_b16 v[66:67], v107 offset:49664
v_mfma_f32_16x16x32_bf16 v[44:47], v[80:83], a[20:23], v[44:47]
v_mfma_f32_16x16x32_bf16 v[48:51], v[80:83], a[84:87], v[48:51]
s_waitcnt lgkmcnt(0)
v_mfma_f32_16x16x32_bf16 v[36:39], v[60:63], a[24:27], v[36:39]
ds_read_b64_tr_b16 v[76:77], v106 offset:53248
ds_read_b64_tr_b16 v[78:79], v106 offset:53760
v_mfma_f32_16x16x32_bf16 v[40:43], v[60:63], a[88:91], v[40:43]
ds_read_b64_tr_b16 v[80:81], v107 offset:53248
ds_read_b64_tr_b16 v[82:83], v107 offset:53760
v_mfma_f32_16x16x32_bf16 v[44:47], v[64:67], a[24:27], v[44:47]
v_mfma_f32_16x16x32_bf16 v[48:51], v[64:67], a[88:91], v[48:51]
s_waitcnt lgkmcnt(0)
s_waitcnt vmcnt(7)
s_barrier
v_add_u32 v109, 65536, v106
v_add_u32 v110, 65536, v107
v_mfma_f32_16x16x32_bf16 v[36:39], v[76:79], a[28:31], v[36:39]
ds_read_b64_tr_b16 v[60:61], v109 offset:0
ds_read_b64_tr_b16 v[62:63], v109 offset:512
v_mfma_f32_16x16x32_bf16 v[40:43], v[76:79], a[92:95], v[40:43]
ds_read_b64_tr_b16 v[64:65], v110 offset:0
ds_read_b64_tr_b16 v[66:67], v110 offset:512
s_add_u32 m0, s74, 32768
s_add_u32 s3, s5, 0
s_and_b32 s3, s3, 3
s_lshl_b32 s3, s3, 8
s_add_u32 s3, s3, 2048
buffer_load_dwordx4 v98, s[52:55], s3 offen offset:0  lds
v_mfma_f32_16x16x32_bf16 v[44:47], v[80:83], a[28:31], v[44:47]
v_mfma_f32_16x16x32_bf16 v[48:51], v[80:83], a[92:95], v[48:51]
buffer_load_dwordx4 v99, s[52:55], s3 offen offset:1024  lds
s_waitcnt lgkmcnt(0)
v_mfma_f32_16x16x32_bf16 v[36:39], v[60:63], a[32:35], v[36:39]
ds_read_b64_tr_b16 v[76:77], v109 offset:4096
ds_read_b64_tr_b16 v[78:79], v109 offset:4608
v_mfma_f32_16x16x32_bf16 v[40:43], v[60:63], a[96:99], v[40:43]
ds_read_b64_tr_b16 v[80:81], v110 offset:4096
ds_read_b64_tr_b16 v[82:83], v110 offset:4608
s_add_u32 m0, s74, 49152
s_add_u32 s3, s5, 0
s_and_b32 s3, s3, 3
s_lshl_b32 s3, s3, 8
s_add_u32 s3, s3, 3072
buffer_load_dwordx4 v98, s[52:55], s3 offen offset:0  lds
v_mfma_f32_16x16x32_bf16 v[44:47], v[64:67], a[32:35], v[44:47]
v_mfma_f32_16x16x32_bf16 v[48:51], v[64:67], a[96:99], v[48:51]
buffer_load_dwordx4 v99, s[52:55], s3 offen offset:1024  lds
s_waitcnt lgkmcnt(0)
v_add_u32 v109, 81920, v106
v_add_u32 v110, 81920, v107
v_mfma_f32_16x16x32_bf16 v[36:39], v[76:79], a[36:39], v[36:39]
ds_read_b64_tr_b16 v[60:61], v109 offset:0
ds_read_b64_tr_b16 v[62:63], v109 offset:512
v_mfma_f32_16x16x32_bf16 v[40:43], v[76:79], a[100:103], v[40:43]
ds_read_b64_tr_b16 v[64:65], v110 offset:0
ds_read_b64_tr_b16 v[66:67], v110 offset:512
v_mfma_f32_16x16x32_bf16 v[44:47], v[80:83], a[36:39], v[44:47]
v_mfma_f32_16x16x32_bf16 v[48:51], v[80:83], a[100:103], v[48:51]
s_waitcnt lgkmcnt(0)
v_mfma_f32_16x16x32_bf16 v[36:39], v[60:63], a[40:43], v[36:39]
ds_read_b64_tr_b16 v[76:77], v109 offset:4096
ds_read_b64_tr_b16 v[78:79], v109 offset:4608
v_mfma_f32_16x16x32_bf16 v[40:43], v[60:63], a[104:107], v[40:43]
ds_read_b64_tr_b16 v[80:81], v110 offset:4096
ds_read_b64_tr_b16 v[82:83], v110 offset:4608
v_mfma_f32_16x16x32_bf16 v[44:47], v[64:67], a[40:43], v[44:47]
v_mfma_f32_16x16x32_bf16 v[48:51], v[64:67], a[104:107], v[48:51]
s_waitcnt lgkmcnt(0)
s_waitcnt vmcnt(8)
s_barrier
v_add_u32 v109, 98304, v106
v_add_u32 v110, 98304, v107
v_mfma_f32_16x16x32_bf16 v[36:39], v[76:79], a[44:47], v[36:39]
ds_read_b64_tr_b16 v[60:61], v109 offset:0
ds_read_b64_tr_b16 v[62:63], v109 offset:512
v_mfma_f32_16x16x32_bf16 v[40:43], v[76:79], a[108:111], v[40:43]
ds_read_b64_tr_b16 v[64:65], v110 offset:0
ds_read_b64_tr_b16 v[66:67], v110 offset:512
s_add_u32 m0, s74, 65536
s_add_u32 s3, s5, 1
s_and_b32 s3, s3, 3
s_lshl_b32 s3, s3, 8
buffer_load_dwordx4 v98, s[52:55], s3 offen offset:0  lds
v_mfma_f32_16x16x32_bf16 v[44:47], v[80:83], a[44:47], v[44:47]
v_mfma_f32_16x16x32_bf16 v[48:51], v[80:83], a[108:111], v[48:51]
buffer_load_dwordx4 v99, s[52:55], s3 offen offset:1024  lds
s_waitcnt lgkmcnt(0)
v_mfma_f32_16x16x32_bf16 v[36:39], v[60:63], a[48:51], v[36:39]
ds_read_b64_tr_b16 v[76:77], v109 offset:4096
ds_read_b64_tr_b16 v[78:79], v109 offset:4608
v_mfma_f32_16x16x32_bf16 v[40:43], v[60:63], a[112:115], v[40:43]
ds_read_b64_tr_b16 v[80:81], v110 offset:4096
ds_read_b64_tr_b16 v[82:83], v110 offset:4608
s_add_u32 m0, s74, 81920
s_add_u32 s3, s5, 1
s_and_b32 s3, s3, 3
s_lshl_b32 s3, s3, 8
s_add_u32 s3, s3, 1024
buffer_load_dwordx4 v98, s[52:55], s3 offen offset:0  lds
v_mfma_f32_16x16x32_bf16 v[44:47], v[64:67], a[48:51], v[44:47]
v_mfma_f32_16x16x32_bf16 v[48:51], v[64:67], a[112:115], v[48:51]
buffer_load_dwordx4 v99, s[52:55], s3 offen offset:1024  lds
s_waitcnt lgkmcnt(0)
v_add_u32 v109, 114688, v106
v_add_u32 v110, 114688, v107
v_mfma_f32_16x16x32_bf16 v[36:39], v[76:79], a[52:55], v[36:39]
ds_read_b64_tr_b16 v[60:61], v109 offset:0
ds_read_b64_tr_b16 v[62:63], v109 offset:512
v_mfma_f32_16x16x32_bf16 v[40:43], v[76:79], a[116:119], v[40:43]
ds_read_b64_tr_b16 v[64:65], v110 offset:0
ds_read_b64_tr_b16 v[66:67], v110 offset:512
v_mfma_f32_16x16x32_bf16 v[44:47], v[80:83], a[52:55], v[44:47]
v_mfma_f32_16x16x32_bf16 v[48:51], v[80:83], a[116:119], v[48:51]
s_waitcnt lgkmcnt(0)
v_mfma_f32_16x16x32_bf16 v[36:39], v[60:63], a[56:59], v[36:39]
ds_read_b64_tr_b16 v[76:77], v109 offset:4096
ds_read_b64_tr_b16 v[78:79], v109 offset:4608
v_mfma_f32_16x16x32_bf16 v[40:43], v[60:63], a[120:123], v[40:43]
ds_read_b64_tr_b16 v[80:81], v110 offset:4096
ds_read_b64_tr_b16 v[82:83], v110 offset:4608
v_mfma_f32_16x16x32_bf16 v[44:47], v[64:67], a[56:59], v[44:47]
v_mfma_f32_16x16x32_bf16 v[48:51], v[64:67], a[120:123], v[48:51]
s_waitcnt lgkmcnt(0)
v_mfma_f32_16x16x32_bf16 v[36:39], v[76:79], a[60:63], v[36:39]
v_mfma_f32_16x16x32_bf16 v[40:43], v[76:79], a[124:127], v[40:43]
v_mfma_f32_16x16x32_bf16 v[44:47], v[80:83], a[60:63], v[44:47]
v_mfma_f32_16x16x32_bf16 v[48:51], v[80:83], a[124:127], v[48:51]
s_barrier
s_cmp_lt_u32 s6, 6
s_cbranch_scc1 if_15
s_and_b32 s60, s2, 7
s_lshl_b32 s60, s60, 4
s_lshr_b32 s61, s2, 3
s_and_b32 s61, s61, 15
s_add_u32 s60, s60, s61
s_mul_i32 s60, s60, 75
s_sub_u32 s61, s6, 6
s_mul_i32 s61, s61, 40
s_add_u32 s60, s60, s61
s_mov_b64 s[68:69], exec
s_mov_b32 exec_hi, 0xff
s_mov_b32 s56, s20
s_and_b32 s57, s21, 0xffff
s_mov_b32 s58, 0x80000
s_mov_b32 s59, 0x00020000
v_add_u32 v1, s60, v0
v_lshlrev_b32 v1, 7, v1
buffer_load_dword v3, v1, s[56:59], 0 offen
s_mov_b32 s56, s30
s_and_b32 s57, s31, 0xffff
s_mov_b32 s58, 0xac000
s_mov_b32 s59, 0x00020000
v_subrev_u32 v1, 0x80000, v1
buffer_load_dword v3, v1, s[56:59], 0 offen
s_mov_b64 exec, s[68:69]
if_15:
s_mov_b32 s76, 0x3fb8aa3b
s_mov_b32 s77, 0x3fb8aa3b
s_mov_b32 s78, 0x358637bd
s_mov_b32 s79, 0x358637bd
v_pk_mul_f32 v[68:69], v[36:37], s[76:77]
v_pk_mul_f32 v[70:71], v[38:39], s[76:77]
v_pk_mul_f32 v[72:73], v[40:41], s[76:77]
v_pk_mul_f32 v[74:75], v[42:43], s[76:77]
v_exp_f32 v68, v68 clamp
v_exp_f32 v69, v69 clamp
v_exp_f32 v70, v70 clamp
v_exp_f32 v71, v71 clamp
v_exp_f32 v72, v72 clamp
v_exp_f32 v73, v73 clamp
v_exp_f32 v74, v74 clamp
v_exp_f32 v75, v75 clamp
v_max_f32 v36, 0, v36
v_max_f32 v37, 0, v37
v_max_f32 v38, 0, v38
v_max_f32 v39, 0, v39
v_max_f32 v40, 0, v40
v_max_f32 v41, 0, v41
v_max_f32 v42, 0, v42
v_max_f32 v43, 0, v43
v_pk_add_f32 v[68:69], v[68:69], s[78:79]
v_pk_add_f32 v[70:71], v[70:71], s[78:79]
v_pk_add_f32 v[72:73], v[72:73], s[78:79]
v_pk_add_f32 v[74:75], v[74:75], s[78:79]
v_pk_add_f32 v[36:37], v[36:37], v[68:69]
v_pk_add_f32 v[38:39], v[38:39], v[70:71]
v_pk_add_f32 v[40:41], v[40:41], v[72:73]
v_pk_add_f32 v[42:43], v[42:43], v[74:75]
v_pk_mul_f32 v[68:69], v[44:45], s[76:77]
v_pk_mul_f32 v[70:71], v[46:47], s[76:77]
v_pk_mul_f32 v[72:73], v[48:49], s[76:77]
v_pk_mul_f32 v[74:75], v[50:51], s[76:77]
v_exp_f32 v68, v68 clamp
v_exp_f32 v69, v69 clamp
v_exp_f32 v70, v70 clamp
v_exp_f32 v71, v71 clamp
v_exp_f32 v72, v72 clamp
v_exp_f32 v73, v73 clamp
v_exp_f32 v74, v74 clamp
v_exp_f32 v75, v75 clamp
v_max_f32 v44, 0, v44
v_max_f32 v45, 0, v45
v_max_f32 v46, 0, v46
v_max_f32 v47, 0, v47
v_max_f32 v48, 0, v48
v_max_f32 v49, 0, v49
v_max_f32 v50, 0, v50
v_max_f32 v51, 0, v51
v_pk_add_f32 v[68:69], v[68:69], s[78:79]
v_pk_add_f32 v[70:71], v[70:71], s[78:79]
v_pk_add_f32 v[72:73], v[72:73], s[78:79]
v_pk_add_f32 v[74:75], v[74:75], s[78:79]
v_pk_add_f32 v[44:45], v[44:45], v[68:69]
v_pk_add_f32 v[46:47], v[46:47], v[70:71]
v_pk_add_f32 v[48:49], v[48:49], v[72:73]
v_pk_add_f32 v[50:51], v[50:51], v[74:75]
v_lshlrev_b32 v115, 4, v0
s_lshl_b32 s60, s10, 2
s_lshl_b32 s61, s8, 1
s_add_u32 s60, s60, s61
s_lshl_b32 s60, s60, 6
s_lshl_b32 s61, s9, 2
s_add_u32 s60, s60, s61
s_add_u32 s60, s60, s7
s_lshl_b32 s60, s60, 10
s_add_u32 s60, s60, 6291456
v_cvt_pk_bf16_f32 v60, v36, v37
v_cvt_pk_bf16_f32 v61, v38, v39
v_cvt_pk_bf16_f32 v62, v40, v41
v_cvt_pk_bf16_f32 v63, v42, v43
s_add_u32 s61, s60, 0
buffer_store_dwordx4 v[60:63], v115, s[48:51], s61 offen offset:0 sc1
v_cvt_pk_bf16_f32 v64, v44, v45
v_cvt_pk_bf16_f32 v65, v46, v47
v_cvt_pk_bf16_f32 v66, v48, v49
v_cvt_pk_bf16_f32 v67, v50, v51
s_add_u32 s61, s60, 65536
buffer_store_dwordx4 v[64:67], v115, s[48:51], s61 offen offset:0 sc1
s_add_u32 m0, s74, 98304
s_add_u32 s3, s5, 1
s_and_b32 s3, s3, 3
s_lshl_b32 s3, s3, 8
s_add_u32 s3, s3, 2048
buffer_load_dwordx4 v98, s[52:55], s3 offen offset:0  lds
buffer_load_dwordx4 v99, s[52:55], s3 offen offset:1024  lds
s_add_u32 m0, s74, 114688
s_add_u32 s3, s5, 1
s_and_b32 s3, s3, 3
s_lshl_b32 s3, s3, 8
s_add_u32 s3, s3, 3072
buffer_load_dwordx4 v98, s[52:55], s3 offen offset:0  lds
buffer_load_dwordx4 v99, s[52:55], s3 offen offset:1024  lds
v_lshrrev_b32 v115, 4, v0
v_and_b32 v116, 15, v0
v_lshrrev_b32 v117, 1, v115
v_xor_b32 v117, v117, v116
v_lshlrev_b32 v117, 4, v117
v_and_b32 v118, 1, v115
v_lshl_add_u32 v117, v118, 3, v117
v_lshl_add_u32 v117, v116, 8, v117
s_lshl_b32 s60, s8, 13
v_add_u32 v102, s60, v117
v_xor_b32 v103, 32, v102
v_xor_b32 v104, 64, v102
v_xor_b32 v105, 96, v102
v_xor_b32 v106, 128, v102
v_xor_b32 v107, 160, v102
v_xor_b32 v108, 192, v102
v_xor_b32 v109, 224, v102
s_waitcnt vmcnt(10)
s_barrier
s_lshl_b32 s60, s7, 14
s_add_u32 s60, s60, 0
v_add_u32 v60, s60, v102
v_add_u32 v61, s60, v103
v_add_u32 v62, s60, v104
v_add_u32 v63, s60, v105
v_add_u32 v64, s60, v106
v_add_u32 v65, s60, v107
v_add_u32 v66, s60, v108
v_add_u32 v67, s60, v109
ds_read_b64 a[0:1], v60 offset:0
ds_read_b64 a[2:3], v61 offset:0
ds_read_b64 a[64:65], v60 offset:4096
ds_read_b64 a[66:67], v61 offset:4096
ds_read_b64 a[4:5], v62 offset:0
ds_read_b64 a[6:7], v63 offset:0
ds_read_b64 a[68:69], v62 offset:4096
ds_read_b64 a[70:71], v63 offset:4096
ds_read_b64 a[8:9], v64 offset:0
ds_read_b64 a[10:11], v65 offset:0
ds_read_b64 a[72:73], v64 offset:4096
ds_read_b64 a[74:75], v65 offset:4096
s_waitcnt lgkmcnt(6)
ds_read_b64 a[12:13], v66 offset:0
ds_read_b64 a[14:15], v67 offset:0
ds_read_b64 a[76:77], v66 offset:4096
ds_read_b64 a[78:79], v67 offset:4096
s_waitcnt vmcnt(0)
s_barrier
s_cmp_lg_u32 s6, 0
s_cbranch_scc1 if_16
s_lshl_b32 s60, s10, 8
s_add_u32 s60, s60, 15734784
s_mov_b64 s[68:69], exec
s_mov_b64 exec, 1
v_mov_b32 v122, 1
v_mov_b32 v123, 0
buffer_atomic_add v122, v123, s[48:51], s60 offen sc1
s_mov_b64 exec, s[68:69]
if_16:
s_lshl_b32 s60, s7, 14
s_add_u32 s60, s60, 65536
v_add_u32 v60, s60, v102
v_add_u32 v61, s60, v103
v_add_u32 v62, s60, v104
v_add_u32 v63, s60, v105
v_add_u32 v64, s60, v106
v_add_u32 v65, s60, v107
v_add_u32 v66, s60, v108
v_add_u32 v67, s60, v109
ds_read_b64 a[16:17], v60 offset:0
ds_read_b64 a[18:19], v61 offset:0
ds_read_b64 a[80:81], v60 offset:4096
ds_read_b64 a[82:83], v61 offset:4096
ds_read_b64 a[20:21], v62 offset:0
ds_read_b64 a[22:23], v63 offset:0
ds_read_b64 a[84:85], v62 offset:4096
ds_read_b64 a[86:87], v63 offset:4096
ds_read_b64 a[24:25], v64 offset:0
ds_read_b64 a[26:27], v65 offset:0
ds_read_b64 a[88:89], v64 offset:4096
ds_read_b64 a[90:91], v65 offset:4096
s_waitcnt lgkmcnt(6)
ds_read_b64 a[28:29], v66 offset:0
ds_read_b64 a[30:31], v67 offset:0
ds_read_b64 a[92:93], v66 offset:4096
ds_read_b64 a[94:95], v67 offset:4096
s_waitcnt lgkmcnt(0)
s_barrier
s_add_u32 m0, s74, 0
s_add_u32 s3, s5, 2
s_and_b32 s3, s3, 3
s_lshl_b32 s3, s3, 8
buffer_load_dwordx4 v98, s[52:55], s3 offen offset:0  lds
buffer_load_dwordx4 v99, s[52:55], s3 offen offset:1024  lds
s_add_u32 m0, s74, 16384
s_add_u32 s3, s5, 2
s_and_b32 s3, s3, 3
s_lshl_b32 s3, s3, 8
s_add_u32 s3, s3, 1024
buffer_load_dwordx4 v98, s[52:55], s3 offen offset:0  lds
buffer_load_dwordx4 v99, s[52:55], s3 offen offset:1024  lds
s_add_u32 m0, s74, 32768
s_add_u32 s3, s5, 2
s_and_b32 s3, s3, 3
s_lshl_b32 s3, s3, 8
s_add_u32 s3, s3, 2048
buffer_load_dwordx4 v98, s[52:55], s3 offen offset:0  lds
buffer_load_dwordx4 v99, s[52:55], s3 offen offset:1024  lds
s_add_u32 m0, s74, 49152
s_add_u32 s3, s5, 2
s_and_b32 s3, s3, 3
s_lshl_b32 s3, s3, 8
s_add_u32 s3, s3, 3072
buffer_load_dwordx4 v98, s[52:55], s3 offen offset:0  lds
buffer_load_dwordx4 v99, s[52:55], s3 offen offset:1024  lds
s_add_u32 m0, s74, 65536
s_add_u32 s3, s5, 3
s_and_b32 s3, s3, 3
s_lshl_b32 s3, s3, 8
buffer_load_dwordx4 v98, s[52:55], s3 offen offset:0  lds
buffer_load_dwordx4 v99, s[52:55], s3 offen offset:1024  lds
s_add_u32 m0, s74, 81920
s_add_u32 s3, s5, 3
s_and_b32 s3, s3, 3
s_lshl_b32 s3, s3, 8
s_add_u32 s3, s3, 1024
buffer_load_dwordx4 v98, s[52:55], s3 offen offset:0  lds
buffer_load_dwordx4 v99, s[52:55], s3 offen offset:1024  lds
s_add_u32 m0, s74, 98304
s_add_u32 s3, s5, 3
s_and_b32 s3, s3, 3
s_lshl_b32 s3, s3, 8
s_add_u32 s3, s3, 2048
buffer_load_dwordx4 v98, s[52:55], s3 offen offset:0  lds
buffer_load_dwordx4 v99, s[52:55], s3 offen offset:1024  lds
s_add_u32 m0, s74, 114688
s_add_u32 s3, s5, 3
s_and_b32 s3, s3, 3
s_lshl_b32 s3, s3, 8
s_add_u32 s3, s3, 3072
buffer_load_dwordx4 v98, s[52:55], s3 offen offset:0  lds
buffer_load_dwordx4 v99, s[52:55], s3 offen offset:1024  lds
s_waitcnt vmcnt(8)
s_barrier
s_lshl_b32 s60, s7, 14
s_add_u32 s60, s60, 0
v_add_u32 v60, s60, v102
v_add_u32 v61, s60, v103
v_add_u32 v62, s60, v104
v_add_u32 v63, s60, v105
v_add_u32 v64, s60, v106
v_add_u32 v65, s60, v107
v_add_u32 v66, s60, v108
v_add_u32 v67, s60, v109
ds_read_b64 a[32:33], v60 offset:0
ds_read_b64 a[34:35], v61 offset:0
ds_read_b64 a[96:97], v60 offset:4096
ds_read_b64 a[98:99], v61 offset:4096
ds_read_b64 a[36:37], v62 offset:0
ds_read_b64 a[38:39], v63 offset:0
ds_read_b64 a[100:101], v62 offset:4096
ds_read_b64 a[102:103], v63 offset:4096
ds_read_b64 a[40:41], v64 offset:0
ds_read_b64 a[42:43], v65 offset:0
ds_read_b64 a[104:105], v64 offset:4096
ds_read_b64 a[106:107], v65 offset:4096
s_waitcnt lgkmcnt(6)
ds_read_b64 a[44:45], v66 offset:0
ds_read_b64 a[46:47], v67 offset:0
ds_read_b64 a[108:109], v66 offset:4096
ds_read_b64 a[110:111], v67 offset:4096
s_waitcnt vmcnt(0)
s_barrier
s_lshl_b32 s60, s7, 14
s_add_u32 s60, s60, 65536
v_add_u32 v60, s60, v102
v_add_u32 v61, s60, v103
v_add_u32 v62, s60, v104
v_add_u32 v63, s60, v105
v_add_u32 v64, s60, v106
v_add_u32 v65, s60, v107
v_add_u32 v66, s60, v108
v_add_u32 v67, s60, v109
ds_read_b64 a[48:49], v60 offset:0
ds_read_b64 a[50:51], v61 offset:0
ds_read_b64 a[112:113], v60 offset:4096
ds_read_b64 a[114:115], v61 offset:4096
ds_read_b64 a[52:53], v62 offset:0
ds_read_b64 a[54:55], v63 offset:0
ds_read_b64 a[116:117], v62 offset:4096
ds_read_b64 a[118:119], v63 offset:4096
ds_read_b64 a[56:57], v64 offset:0
ds_read_b64 a[58:59], v65 offset:0
ds_read_b64 a[120:121], v64 offset:4096
ds_read_b64 a[122:123], v65 offset:4096
s_waitcnt lgkmcnt(6)
ds_read_b64 a[60:61], v66 offset:0
ds_read_b64 a[62:63], v67 offset:0
ds_read_b64 a[124:125], v66 offset:4096
ds_read_b64 a[126:127], v67 offset:4096
s_waitcnt lgkmcnt(0)
s_branch p1end_4
p1win_3:
s_mov_b32 s44, s24
s_and_b32 s45, s25, 0xffff
s_mov_b32 s46, 0x158000
s_mov_b32 s47, 0x00020000
s_sub_u32 s14, s10, 8
s_mul_i32 s11, s14, 192
s_mov_b32 s12, s11
s_add_u32 s11, s11, 1408
s_cmp_lg_u32 s14, 7
s_cbranch_scc1 if_17
s_mov_b32 s11, 1376
s_mov_b32 s12, 1344
if_17:
s_mul_i32 s100, s15, 176128
s_mov_b32 s101, s100
s_and_b32 s62, s6, 1
s_lshl_b32 s62, s62, 2
v_lshrrev_b32 v119, 1, v118
v_xor_b32 v119, v119, v117
v_xor_b32 v119, s62, v119
v_and_b32 v120, 1, v0
v_lshlrev_b32 v119, 5, v119
v_lshl_add_u32 v119, v120, 4, v119
s_mul_i32 s61, s6, 22016
v_mul_u32_u24 v120, 2752, v117
s_add_u32 s63, s61, s11
v_add_u32 v94, s63, v120
v_add_u32 v95, 11008, v94
v_and_b32 v94, 0xffffff80, v94
v_and_b32 v95, 0xffffff80, v95
v_add_u32 v94, v94, v119
v_add_u32 v95, v95, v119
v_subrev_u32 v95, 1024, v95
s_add_u32 s63, s61, s12
v_add_u32 v96, s63, v120
v_add_u32 v97, 11008, v96
v_and_b32 v96, 0xffffff80, v96
v_and_b32 v97, 0xffffff80, v97
v_add_u32 v96, v96, v119
v_add_u32 v97, v97, v119
v_subrev_u32 v97, 1024, v97
s_add_u32 m0, s74, 16384
s_nop 0
buffer_load_dwordx4 v94, s[44:47], s100 offen offset:0  lds
buffer_load_dwordx4 v95, s[44:47], s100 offen offset:1024  lds
s_add_u32 s100, s100, 176128
s_cmp_eq_u32 s100, 1409024
s_cselect_b32 s100, 0, s100
s_add_u32 m0, s74, 32768
s_nop 0
buffer_load_dwordx4 v92, s[40:43], s99 offen offset:0  lds
buffer_load_dwordx4 v93, s[40:43], s99 offen offset:1024  lds
s_add_u32 s99, s99, 128
s_cmp_eq_u32 s99, 1024
s_cselect_b32 s99, 0, s99
s_add_u32 m0, s74, 49152
s_nop 0
buffer_load_dwordx4 v94, s[44:47], s100 offen offset:0  lds
buffer_load_dwordx4 v95, s[44:47], s100 offen offset:1024  lds
s_add_u32 s100, s100, 176128
s_cmp_eq_u32 s100, 1409024
s_cselect_b32 s100, 0, s100
s_mov_b32 s48, s38
s_and_b32 s49, s39, 0xffff
s_mov_b32 s50, 0xf10000
s_mov_b32 s51, 0x00020000
s_mov_b32 s92, s36
s_and_b32 s93, s37, 0xffff
s_mov_b32 s94, 0x100
s_mov_b32 s95, 0x00020000
s_mov_b32 s52, s26
s_and_b32 s53, s27, 0xffff
s_mov_b32 s54, 0x800000
s_mov_b32 s55, 0x00020000
s_cmp_lg_u32 s2, 0
s_cbranch_scc1 init_18
s_cmp_lg_u32 s6, 0
s_cbranch_scc1 init_18
v_lshlrev_b32 v2, 8, v0
v_mov_b32 v3, 0
s_mov_b32 s60, 15728640
buffer_store_dword v3, v2, s[48:51], s60 offen sc1
s_add_u32 s60, s60, 16384
buffer_store_dword v3, v2, s[48:51], s60 offen sc1
init_18:
s_cmp_lg_u32 s6, 0
s_cbranch_scc1 if_19
v_mov_b32 v2, 159744
v_mov_b32 v3, 0
ds_write_b32 v2, v3 offset:0
ds_write_b32 v2, v3 offset:4
ds_write_b32 v2, v3 offset:8
ds_write_b32 v2, v3 offset:12
ds_write_b32 v2, v3 offset:16
s_waitcnt lgkmcnt(0)
if_19:
s_and_b32 s60, s2, 7
s_lshr_b32 s61, s2, 3
s_lshr_b32 s62, s60, 1
s_lshl_b32 s62, s62, 3
s_and_b32 s63, s61, 7
s_add_u32 s96, s62, s63
s_lshl_b32 s62, s60, 2
s_and_b32 s63, s61, 3
s_add_u32 s97, s62, s63
s_lshr_b32 s98, s61, 2
s_lshr_b32 s63, s61, 3
s_mov_b32 s62, s63
s_and_b32 s5, s62, 3
s_and_b32 s62, s5, 1
s_lshl_b32 s5, s62, 1
s_mul_i32 s70, s14, 6
s_add_u32 s71, s70, 1
s_mov_b32 s13, 3
s_cmp_lg_u32 s14, 7
s_cbranch_scc1 if_20
s_mov_b32 s70, 42
s_mov_b32 s71, 0
s_xor_b32 s13, s8, 1
if_20:
v_lshrrev_b32 v119, 1, v118
v_xor_b32 v119, v119, v117
v_lshlrev_b32 v119, 4, v119
v_lshl_add_u32 v119, v118, 7, v119
s_lshl_b32 s61, s7, 12
v_add_u32 v100, s61, v119
v_xor_b32 v101, 64, v100
v_lshrrev_b32 v109, 2, v118
v_and_b32 v110, 1, v117
v_lshl_or_b32 v110, v110, 2, v109
v_and_b32 v111, 3, v118
v_lshlrev_b32 v111, 3, v111
v_lshl_add_u32 v109, v117, 3, v109
v_lshl_add_u32 v116, v109, 8, v111
v_mul_u32_u24 v115, 2752, v109
s_mul_i32 s61, s8, 3
s_mul_i32 s61, s8, 3
v_add_u32 v119, s11, v115
v_bfe_u32 v119, v119, 5, 2
v_add_u32 v119, s61, v119
v_add_u32 v120, 0, v119
v_and_b32 v120, 7, v120
v_xor_b32 v120, v120, v110
v_lshl_add_u32 v102, v120, 5, v116
v_add_u32 v120, 1, v119
v_and_b32 v120, 7, v120
v_xor_b32 v120, v120, v110
v_lshl_add_u32 v103, v120, 5, v116
v_add_u32 v120, 2, v119
v_and_b32 v120, 7, v120
v_xor_b32 v120, v120, v110
v_lshl_add_u32 v104, v120, 5, v116
s_mul_i32 s61, s8, 4
v_add_u32 v119, s12, v115
v_bfe_u32 v119, v119, 5, 2
v_add_u32 v119, s61, v119
v_add_u32 v120, 0, v119
v_and_b32 v120, 7, v120
v_xor_b32 v120, v120, v110
v_lshl_add_u32 v105, v120, 5, v116
v_add_u32 v120, 1, v119
v_and_b32 v120, 7, v120
v_xor_b32 v120, v120, v110
v_lshl_add_u32 v106, v120, 5, v116
v_add_u32 v120, 2, v119
v_and_b32 v120, 7, v120
v_xor_b32 v120, v120, v110
v_lshl_add_u32 v107, v120, 5, v116
v_add_u32 v120, 3, v119
v_and_b32 v120, 7, v120
v_xor_b32 v120, v120, v110
v_lshl_add_u32 v108, v120, 5, v116
s_waitcnt vmcnt(4)
s_barrier
ds_read_b128 a[0:3], v100 offset:0
ds_read_b128 a[64:67], v100 offset:2048
ds_read_b64_tr_b16 v[60:61], v102 offset:16384
ds_read_b64_tr_b16 v[62:63], v102 offset:17408
ds_read_b64_tr_b16 v[64:65], v103 offset:16384
ds_read_b64_tr_b16 v[66:67], v103 offset:17408
ds_read_b64_tr_b16 v[68:69], v104 offset:16384
ds_read_b64_tr_b16 v[70:71], v104 offset:17408
s_add_u32 m0, s74, 65536
s_nop 0
buffer_load_dwordx4 v92, s[40:43], s99 offen offset:0  lds
buffer_load_dwordx4 v93, s[40:43], s99 offen offset:1024  lds
s_add_u32 s99, s99, 128
s_cmp_eq_u32 s99, 1024
s_cselect_b32 s99, 0, s99
s_waitcnt lgkmcnt(0)
v_mfma_f32_16x16x32_bf16 v[4:7], v[60:63], a[0:3], 0
ds_read_b128 a[4:7], v101 offset:0
ds_read_b128 a[68:71], v101 offset:2048
v_mfma_f32_16x16x32_bf16 v[8:11], v[60:63], a[64:67], 0
ds_read_b64_tr_b16 v[76:77], v102 offset:24576
ds_read_b64_tr_b16 v[78:79], v102 offset:25600
s_add_u32 m0, s74, 81920
s_nop 0
buffer_load_dwordx4 v94, s[44:47], s100 offen offset:0  lds
v_mfma_f32_16x16x32_bf16 v[12:15], v[64:67], a[0:3], 0
ds_read_b64_tr_b16 v[80:81], v103 offset:24576
ds_read_b64_tr_b16 v[82:83], v103 offset:25600
v_mfma_f32_16x16x32_bf16 v[16:19], v[64:67], a[64:67], 0
ds_read_b64_tr_b16 v[84:85], v104 offset:24576
ds_read_b64_tr_b16 v[86:87], v104 offset:25600
v_mfma_f32_16x16x32_bf16 v[20:23], v[68:71], a[0:3], 0
buffer_load_dwordx4 v95, s[44:47], s100 offen offset:1024  lds
s_add_u32 s100, s100, 176128
s_cmp_eq_u32 s100, 1409024
s_cselect_b32 s100, 0, s100
v_mfma_f32_16x16x32_bf16 v[24:27], v[68:71], a[64:67], 0
s_waitcnt lgkmcnt(0)
s_waitcnt vmcnt(4)
s_barrier
v_mfma_f32_16x16x32_bf16 v[4:7], v[76:79], a[4:7], v[4:7]
ds_read_b128 a[8:11], v100 offset:32768
ds_read_b128 a[72:75], v100 offset:34816
v_mfma_f32_16x16x32_bf16 v[8:11], v[76:79], a[68:71], v[8:11]
ds_read_b64_tr_b16 v[60:61], v102 offset:49152
ds_read_b64_tr_b16 v[62:63], v102 offset:50176
s_add_u32 m0, s74, 98304
s_nop 0
buffer_load_dwordx4 v92, s[40:43], s99 offen offset:0  lds
v_mfma_f32_16x16x32_bf16 v[12:15], v[80:83], a[4:7], v[12:15]
ds_read_b64_tr_b16 v[64:65], v103 offset:49152
ds_read_b64_tr_b16 v[66:67], v103 offset:50176
v_mfma_f32_16x16x32_bf16 v[16:19], v[80:83], a[68:71], v[16:19]
ds_read_b64_tr_b16 v[68:69], v104 offset:49152
ds_read_b64_tr_b16 v[70:71], v104 offset:50176
v_mfma_f32_16x16x32_bf16 v[20:23], v[84:87], a[4:7], v[20:23]
buffer_load_dwordx4 v93, s[40:43], s99 offen offset:1024  lds
s_add_u32 s99, s99, 128
s_cmp_eq_u32 s99, 1024
s_cselect_b32 s99, 0, s99
v_mfma_f32_16x16x32_bf16 v[24:27], v[84:87], a[68:71], v[24:27]
s_waitcnt lgkmcnt(0)
v_mfma_f32_16x16x32_bf16 v[4:7], v[60:63], a[8:11], v[4:7]
ds_read_b128 a[12:15], v101 offset:32768
ds_read_b128 a[76:79], v101 offset:34816
v_mfma_f32_16x16x32_bf16 v[8:11], v[60:63], a[72:75], v[8:11]
ds_read_b64_tr_b16 v[76:77], v102 offset:57344
ds_read_b64_tr_b16 v[78:79], v102 offset:58368
s_add_u32 m0, s74, 114688
s_nop 0
buffer_load_dwordx4 v94, s[44:47], s100 offen offset:0  lds
v_mfma_f32_16x16x32_bf16 v[12:15], v[64:67], a[8:11], v[12:15]
ds_read_b64_tr_b16 v[80:81], v103 offset:57344
ds_read_b64_tr_b16 v[82:83], v103 offset:58368
v_mfma_f32_16x16x32_bf16 v[16:19], v[64:67], a[72:75], v[16:19]
ds_read_b64_tr_b16 v[84:85], v104 offset:57344
ds_read_b64_tr_b16 v[86:87], v104 offset:58368
v_mfma_f32_16x16x32_bf16 v[20:23], v[68:71], a[8:11], v[20:23]
buffer_load_dwordx4 v95, s[44:47], s100 offen offset:1024  lds
s_add_u32 s100, s100, 176128
s_cmp_eq_u32 s100, 1409024
s_cselect_b32 s100, 0, s100
v_mfma_f32_16x16x32_bf16 v[24:27], v[68:71], a[72:75], v[24:27]
s_waitcnt lgkmcnt(0)
s_waitcnt vmcnt(4)
s_barrier
v_add_u32 v109, 81920, v102
v_add_u32 v110, 81920, v103
v_add_u32 v111, 81920, v104
v_add_u32 v113, 65536, v100
v_add_u32 v114, 65536, v101
v_mfma_f32_16x16x32_bf16 v[4:7], v[76:79], a[12:15], v[4:7]
ds_read_b128 a[16:19], v113 offset:0
ds_read_b128 a[80:83], v113 offset:2048
v_mfma_f32_16x16x32_bf16 v[8:11], v[76:79], a[76:79], v[8:11]
ds_read_b64_tr_b16 v[60:61], v109 offset:0
ds_read_b64_tr_b16 v[62:63], v109 offset:1024
s_add_u32 m0, s74, 0
s_nop 0
buffer_load_dwordx4 v92, s[40:43], s99 offen offset:0  lds
v_mfma_f32_16x16x32_bf16 v[12:15], v[80:83], a[12:15], v[12:15]
ds_read_b64_tr_b16 v[64:65], v110 offset:0
ds_read_b64_tr_b16 v[66:67], v110 offset:1024
v_mfma_f32_16x16x32_bf16 v[16:19], v[80:83], a[76:79], v[16:19]
ds_read_b64_tr_b16 v[68:69], v111 offset:0
ds_read_b64_tr_b16 v[70:71], v111 offset:1024
v_mfma_f32_16x16x32_bf16 v[20:23], v[84:87], a[12:15], v[20:23]
buffer_load_dwordx4 v93, s[40:43], s99 offen offset:1024  lds
s_add_u32 s99, s99, 128
s_cmp_eq_u32 s99, 1024
s_cselect_b32 s99, 0, s99
v_mfma_f32_16x16x32_bf16 v[24:27], v[84:87], a[76:79], v[24:27]
s_waitcnt lgkmcnt(0)
v_mfma_f32_16x16x32_bf16 v[4:7], v[60:63], a[16:19], v[4:7]
ds_read_b128 a[20:23], v114 offset:0
ds_read_b128 a[84:87], v114 offset:2048
v_mfma_f32_16x16x32_bf16 v[8:11], v[60:63], a[80:83], v[8:11]
ds_read_b64_tr_b16 v[76:77], v109 offset:8192
ds_read_b64_tr_b16 v[78:79], v109 offset:9216
s_add_u32 m0, s74, 16384
s_nop 0
buffer_load_dwordx4 v94, s[44:47], s100 offen offset:0  lds
v_mfma_f32_16x16x32_bf16 v[12:15], v[64:67], a[16:19], v[12:15]
ds_read_b64_tr_b16 v[80:81], v110 offset:8192
ds_read_b64_tr_b16 v[82:83], v110 offset:9216
v_mfma_f32_16x16x32_bf16 v[16:19], v[64:67], a[80:83], v[16:19]
ds_read_b64_tr_b16 v[84:85], v111 offset:8192
ds_read_b64_tr_b16 v[86:87], v111 offset:9216
v_mfma_f32_16x16x32_bf16 v[20:23], v[68:71], a[16:19], v[20:23]
buffer_load_dwordx4 v95, s[44:47], s100 offen offset:1024  lds
s_add_u32 s100, s100, 176128
s_cmp_eq_u32 s100, 1409024
s_cselect_b32 s100, 0, s100
v_mfma_f32_16x16x32_bf16 v[24:27], v[68:71], a[80:83], v[24:27]
s_waitcnt lgkmcnt(0)
s_waitcnt vmcnt(4)
s_barrier
v_add_u32 v109, 114688, v102
v_add_u32 v110, 114688, v103
v_add_u32 v111, 114688, v104
v_add_u32 v113, 98304, v100
v_add_u32 v114, 98304, v101
v_mfma_f32_16x16x32_bf16 v[4:7], v[76:79], a[20:23], v[4:7]
ds_read_b128 a[24:27], v113 offset:0
ds_read_b128 a[88:91], v113 offset:2048
v_mfma_f32_16x16x32_bf16 v[8:11], v[76:79], a[84:87], v[8:11]
ds_read_b64_tr_b16 v[60:61], v109 offset:0
ds_read_b64_tr_b16 v[62:63], v109 offset:1024
s_add_u32 m0, s74, 32768
s_nop 0
buffer_load_dwordx4 v92, s[40:43], s99 offen offset:0  lds
v_mfma_f32_16x16x32_bf16 v[12:15], v[80:83], a[20:23], v[12:15]
ds_read_b64_tr_b16 v[64:65], v110 offset:0
ds_read_b64_tr_b16 v[66:67], v110 offset:1024
v_mfma_f32_16x16x32_bf16 v[16:19], v[80:83], a[84:87], v[16:19]
ds_read_b64_tr_b16 v[68:69], v111 offset:0
ds_read_b64_tr_b16 v[70:71], v111 offset:1024
v_mfma_f32_16x16x32_bf16 v[20:23], v[84:87], a[20:23], v[20:23]
buffer_load_dwordx4 v93, s[40:43], s99 offen offset:1024  lds
s_add_u32 s99, s99, 128
s_cmp_eq_u32 s99, 1024
s_cselect_b32 s99, 0, s99
v_mfma_f32_16x16x32_bf16 v[24:27], v[84:87], a[84:87], v[24:27]
s_waitcnt lgkmcnt(0)
v_mfma_f32_16x16x32_bf16 v[4:7], v[60:63], a[24:27], v[4:7]
ds_read_b128 a[28:31], v114 offset:0
ds_read_b128 a[92:95], v114 offset:2048
v_mfma_f32_16x16x32_bf16 v[8:11], v[60:63], a[88:91], v[8:11]
ds_read_b64_tr_b16 v[76:77], v109 offset:8192
ds_read_b64_tr_b16 v[78:79], v109 offset:9216
s_add_u32 m0, s74, 49152
s_nop 0
buffer_load_dwordx4 v94, s[44:47], s100 offen offset:0  lds
v_mfma_f32_16x16x32_bf16 v[12:15], v[64:67], a[24:27], v[12:15]
ds_read_b64_tr_b16 v[80:81], v110 offset:8192
ds_read_b64_tr_b16 v[82:83], v110 offset:9216
v_mfma_f32_16x16x32_bf16 v[16:19], v[64:67], a[88:91], v[16:19]
ds_read_b64_tr_b16 v[84:85], v111 offset:8192
ds_read_b64_tr_b16 v[86:87], v111 offset:9216
v_mfma_f32_16x16x32_bf16 v[20:23], v[68:71], a[24:27], v[20:23]
buffer_load_dwordx4 v95, s[44:47], s100 offen offset:1024  lds
s_add_u32 s100, s100, 176128
s_cmp_eq_u32 s100, 1409024
s_cselect_b32 s100, 0, s100
v_mfma_f32_16x16x32_bf16 v[24:27], v[68:71], a[88:91], v[24:27]
s_waitcnt lgkmcnt(0)
s_waitcnt vmcnt(4)
s_barrier
v_mfma_f32_16x16x32_bf16 v[4:7], v[76:79], a[28:31], v[4:7]
ds_read_b128 a[32:35], v100 offset:0
ds_read_b128 a[96:99], v100 offset:2048
v_mfma_f32_16x16x32_bf16 v[8:11], v[76:79], a[92:95], v[8:11]
ds_read_b64_tr_b16 v[60:61], v102 offset:16384
ds_read_b64_tr_b16 v[62:63], v102 offset:17408
s_add_u32 m0, s74, 65536
s_nop 0
buffer_load_dwordx4 v92, s[40:43], s99 offen offset:0  lds
v_mfma_f32_16x16x32_bf16 v[12:15], v[80:83], a[28:31], v[12:15]
ds_read_b64_tr_b16 v[64:65], v103 offset:16384
ds_read_b64_tr_b16 v[66:67], v103 offset:17408
v_mfma_f32_16x16x32_bf16 v[16:19], v[80:83], a[92:95], v[16:19]
ds_read_b64_tr_b16 v[68:69], v104 offset:16384
ds_read_b64_tr_b16 v[70:71], v104 offset:17408
v_mfma_f32_16x16x32_bf16 v[20:23], v[84:87], a[28:31], v[20:23]
buffer_load_dwordx4 v93, s[40:43], s99 offen offset:1024  lds
s_add_u32 s99, s99, 128
s_cmp_eq_u32 s99, 1024
s_cselect_b32 s99, 0, s99
v_mfma_f32_16x16x32_bf16 v[24:27], v[84:87], a[92:95], v[24:27]
s_waitcnt lgkmcnt(0)
v_mfma_f32_16x16x32_bf16 v[4:7], v[60:63], a[32:35], v[4:7]
ds_read_b128 a[36:39], v101 offset:0
ds_read_b128 a[100:103], v101 offset:2048
v_mfma_f32_16x16x32_bf16 v[8:11], v[60:63], a[96:99], v[8:11]
ds_read_b64_tr_b16 v[76:77], v102 offset:24576
ds_read_b64_tr_b16 v[78:79], v102 offset:25600
s_add_u32 m0, s74, 81920
s_nop 0
buffer_load_dwordx4 v94, s[44:47], s100 offen offset:0  lds
v_mfma_f32_16x16x32_bf16 v[12:15], v[64:67], a[32:35], v[12:15]
ds_read_b64_tr_b16 v[80:81], v103 offset:24576
ds_read_b64_tr_b16 v[82:83], v103 offset:25600
v_mfma_f32_16x16x32_bf16 v[16:19], v[64:67], a[96:99], v[16:19]
ds_read_b64_tr_b16 v[84:85], v104 offset:24576
ds_read_b64_tr_b16 v[86:87], v104 offset:25600
v_mfma_f32_16x16x32_bf16 v[20:23], v[68:71], a[32:35], v[20:23]
buffer_load_dwordx4 v95, s[44:47], s100 offen offset:1024  lds
s_add_u32 s100, s100, 176128
s_cmp_eq_u32 s100, 1409024
s_cselect_b32 s100, 0, s100
v_mfma_f32_16x16x32_bf16 v[24:27], v[68:71], a[96:99], v[24:27]
s_waitcnt lgkmcnt(0)
s_waitcnt vmcnt(4)
s_barrier
v_mfma_f32_16x16x32_bf16 v[4:7], v[76:79], a[36:39], v[4:7]
ds_read_b128 a[40:43], v100 offset:32768
ds_read_b128 a[104:107], v100 offset:34816
v_mfma_f32_16x16x32_bf16 v[8:11], v[76:79], a[100:103], v[8:11]
ds_read_b64_tr_b16 v[60:61], v102 offset:49152
ds_read_b64_tr_b16 v[62:63], v102 offset:50176
s_add_u32 m0, s74, 98304
s_nop 0
buffer_load_dwordx4 v92, s[40:43], s99 offen offset:0  lds
v_mfma_f32_16x16x32_bf16 v[12:15], v[80:83], a[36:39], v[12:15]
ds_read_b64_tr_b16 v[64:65], v103 offset:49152
ds_read_b64_tr_b16 v[66:67], v103 offset:50176
v_mfma_f32_16x16x32_bf16 v[16:19], v[80:83], a[100:103], v[16:19]
ds_read_b64_tr_b16 v[68:69], v104 offset:49152
ds_read_b64_tr_b16 v[70:71], v104 offset:50176
v_mfma_f32_16x16x32_bf16 v[20:23], v[84:87], a[36:39], v[20:23]
buffer_load_dwordx4 v93, s[40:43], s99 offen offset:1024  lds
s_add_u32 s99, s99, 128
s_cmp_eq_u32 s99, 1024
s_cselect_b32 s99, 0, s99
v_mfma_f32_16x16x32_bf16 v[24:27], v[84:87], a[100:103], v[24:27]
s_waitcnt lgkmcnt(0)
v_mfma_f32_16x16x32_bf16 v[4:7], v[60:63], a[40:43], v[4:7]
ds_read_b128 a[44:47], v101 offset:32768
ds_read_b128 a[108:111], v101 offset:34816
v_mfma_f32_16x16x32_bf16 v[8:11], v[60:63], a[104:107], v[8:11]
ds_read_b64_tr_b16 v[76:77], v102 offset:57344
ds_read_b64_tr_b16 v[78:79], v102 offset:58368
s_add_u32 m0, s74, 114688
s_nop 0
buffer_load_dwordx4 v94, s[44:47], s100 offen offset:0  lds
v_mfma_f32_16x16x32_bf16 v[12:15], v[64:67], a[40:43], v[12:15]
ds_read_b64_tr_b16 v[80:81], v103 offset:57344
ds_read_b64_tr_b16 v[82:83], v103 offset:58368
v_mfma_f32_16x16x32_bf16 v[16:19], v[64:67], a[104:107], v[16:19]
ds_read_b64_tr_b16 v[84:85], v104 offset:57344
ds_read_b64_tr_b16 v[86:87], v104 offset:58368
v_mfma_f32_16x16x32_bf16 v[20:23], v[68:71], a[40:43], v[20:23]
buffer_load_dwordx4 v95, s[44:47], s100 offen offset:1024  lds
s_add_u32 s100, s100, 176128
s_cmp_eq_u32 s100, 1409024
s_cselect_b32 s100, 0, s100
v_mfma_f32_16x16x32_bf16 v[24:27], v[68:71], a[104:107], v[24:27]
s_waitcnt lgkmcnt(0)
s_waitcnt vmcnt(4)
s_barrier
v_add_u32 v109, 81920, v102
v_add_u32 v110, 81920, v103
v_add_u32 v111, 81920, v104
v_add_u32 v113, 65536, v100
v_add_u32 v114, 65536, v101
v_mfma_f32_16x16x32_bf16 v[4:7], v[76:79], a[44:47], v[4:7]
ds_read_b128 a[48:51], v113 offset:0
ds_read_b128 a[112:115], v113 offset:2048
v_mfma_f32_16x16x32_bf16 v[8:11], v[76:79], a[108:111], v[8:11]
ds_read_b64_tr_b16 v[60:61], v109 offset:0
ds_read_b64_tr_b16 v[62:63], v109 offset:1024
v_mfma_f32_16x16x32_bf16 v[12:15], v[80:83], a[44:47], v[12:15]
ds_read_b64_tr_b16 v[64:65], v110 offset:0
ds_read_b64_tr_b16 v[66:67], v110 offset:1024
v_mfma_f32_16x16x32_bf16 v[16:19], v[80:83], a[108:111], v[16:19]
ds_read_b64_tr_b16 v[68:69], v111 offset:0
ds_read_b64_tr_b16 v[70:71], v111 offset:1024
v_mfma_f32_16x16x32_bf16 v[20:23], v[84:87], a[44:47], v[20:23]
v_mfma_f32_16x16x32_bf16 v[24:27], v[84:87], a[108:111], v[24:27]
s_waitcnt lgkmcnt(0)
v_mfma_f32_16x16x32_bf16 v[4:7], v[60:63], a[48:51], v[4:7]
ds_read_b128 a[52:55], v114 offset:0
ds_read_b128 a[116:119], v114 offset:2048
v_mfma_f32_16x16x32_bf16 v[8:11], v[60:63], a[112:115], v[8:11]
ds_read_b64_tr_b16 v[76:77], v109 offset:8192
ds_read_b64_tr_b16 v[78:79], v109 offset:9216
v_mfma_f32_16x16x32_bf16 v[12:15], v[64:67], a[48:51], v[12:15]
ds_read_b64_tr_b16 v[80:81], v110 offset:8192
ds_read_b64_tr_b16 v[82:83], v110 offset:9216
v_mfma_f32_16x16x32_bf16 v[16:19], v[64:67], a[112:115], v[16:19]
ds_read_b64_tr_b16 v[84:85], v111 offset:8192
ds_read_b64_tr_b16 v[86:87], v111 offset:9216
v_mfma_f32_16x16x32_bf16 v[20:23], v[68:71], a[48:51], v[20:23]
v_mfma_f32_16x16x32_bf16 v[24:27], v[68:71], a[112:115], v[24:27]
s_waitcnt lgkmcnt(0)
s_waitcnt vmcnt(0)
s_barrier
v_add_u32 v109, 114688, v102
v_add_u32 v110, 114688, v103
v_add_u32 v111, 114688, v104
v_add_u32 v113, 98304, v100
v_add_u32 v114, 98304, v101
v_mfma_f32_16x16x32_bf16 v[4:7], v[76:79], a[52:55], v[4:7]
ds_read_b128 a[56:59], v113 offset:0
ds_read_b128 a[120:123], v113 offset:2048
v_mfma_f32_16x16x32_bf16 v[8:11], v[76:79], a[116:119], v[8:11]
ds_read_b64_tr_b16 v[60:61], v109 offset:0
ds_read_b64_tr_b16 v[62:63], v109 offset:1024
v_mfma_f32_16x16x32_bf16 v[12:15], v[80:83], a[52:55], v[12:15]
ds_read_b64_tr_b16 v[64:65], v110 offset:0
ds_read_b64_tr_b16 v[66:67], v110 offset:1024
v_mfma_f32_16x16x32_bf16 v[16:19], v[80:83], a[116:119], v[16:19]
ds_read_b64_tr_b16 v[68:69], v111 offset:0
ds_read_b64_tr_b16 v[70:71], v111 offset:1024
v_mfma_f32_16x16x32_bf16 v[20:23], v[84:87], a[52:55], v[20:23]
v_mfma_f32_16x16x32_bf16 v[24:27], v[84:87], a[116:119], v[24:27]
s_waitcnt lgkmcnt(0)
v_mfma_f32_16x16x32_bf16 v[4:7], v[60:63], a[56:59], v[4:7]
ds_read_b128 a[60:63], v114 offset:0
ds_read_b128 a[124:127], v114 offset:2048
v_mfma_f32_16x16x32_bf16 v[8:11], v[60:63], a[120:123], v[8:11]
ds_read_b64_tr_b16 v[76:77], v109 offset:8192
ds_read_b64_tr_b16 v[78:79], v109 offset:9216
v_mfma_f32_16x16x32_bf16 v[12:15], v[64:67], a[56:59], v[12:15]
ds_read_b64_tr_b16 v[80:81], v110 offset:8192
ds_read_b64_tr_b16 v[82:83], v110 offset:9216
v_mfma_f32_16x16x32_bf16 v[16:19], v[64:67], a[120:123], v[16:19]
ds_read_b64_tr_b16 v[84:85], v111 offset:8192
ds_read_b64_tr_b16 v[86:87], v111 offset:9216
v_mfma_f32_16x16x32_bf16 v[20:23], v[68:71], a[56:59], v[20:23]
v_mfma_f32_16x16x32_bf16 v[24:27], v[68:71], a[120:123], v[24:27]
s_waitcnt lgkmcnt(0)
v_mfma_f32_16x16x32_bf16 v[4:7], v[76:79], a[60:63], v[4:7]
v_mfma_f32_16x16x32_bf16 v[8:11], v[76:79], a[124:127], v[8:11]
v_mfma_f32_16x16x32_bf16 v[12:15], v[80:83], a[60:63], v[12:15]
v_mfma_f32_16x16x32_bf16 v[16:19], v[80:83], a[124:127], v[16:19]
v_mfma_f32_16x16x32_bf16 v[20:23], v[84:87], a[60:63], v[20:23]
v_mfma_f32_16x16x32_bf16 v[24:27], v[84:87], a[124:127], v[24:27]
s_cmp_lg_u32 s8, 0
s_cbranch_scc1 if_21
v_mov_b32 v126, 0
buffer_load_dword v126, v126, s[92:95], 0 offen sc1
if_21:
s_mov_b32 s76, 0xbdd2d3e8
s_mov_b32 s77, 0xbdd2d3e8
s_mov_b32 s78, 1.0
s_mov_b32 s79, 1.0
v_mov_b32 v90, 0xc0135761
v_mov_b32 v91, 0xc0135761
v_pk_mul_f32 v[60:61], v[4:5], v[4:5]
v_pk_mul_f32 v[62:63], v[6:7], v[6:7]
v_pk_mul_f32 v[64:65], v[8:9], v[8:9]
v_pk_mul_f32 v[66:67], v[10:11], v[10:11]
v_pk_fma_f32 v[60:61], v[60:61], s[76:77], v[90:91]
v_pk_fma_f32 v[62:63], v[62:63], s[76:77], v[90:91]
v_pk_fma_f32 v[64:65], v[64:65], s[76:77], v[90:91]
v_pk_fma_f32 v[66:67], v[66:67], s[76:77], v[90:91]
s_add_u32 m0, s74, 0
s_nop 0
buffer_load_dwordx4 v96, s[44:47], s101 offen offset:0  lds
v_pk_mul_f32 v[60:61], v[60:61], v[4:5]
v_pk_mul_f32 v[62:63], v[62:63], v[6:7]
v_pk_mul_f32 v[64:65], v[64:65], v[8:9]
v_pk_mul_f32 v[66:67], v[66:67], v[10:11]
v_exp_f32 v60, v60
v_exp_f32 v61, v61
v_exp_f32 v62, v62
v_exp_f32 v63, v63
buffer_load_dwordx4 v97, s[44:47], s101 offen offset:1024  lds
s_add_u32 s101, s101, 176128
s_cmp_eq_u32 s101, 1409024
s_cselect_b32 s101, 0, s101
v_exp_f32 v64, v64
v_exp_f32 v65, v65
v_exp_f32 v66, v66
v_exp_f32 v67, v67
v_pk_add_f32 v[60:61], v[60:61], s[78:79]
v_pk_add_f32 v[62:63], v[62:63], s[78:79]
v_pk_add_f32 v[64:65], v[64:65], s[78:79]
v_pk_add_f32 v[66:67], v[66:67], s[78:79]
s_add_u32 m0, s74, 16384
s_nop 0
buffer_load_dwordx4 v96, s[44:47], s101 offen offset:0  lds
v_rcp_f32 v60, v60
v_rcp_f32 v61, v61
v_rcp_f32 v62, v62
v_rcp_f32 v63, v63
v_rcp_f32 v64, v64
v_rcp_f32 v65, v65
v_rcp_f32 v66, v66
v_rcp_f32 v67, v67
buffer_load_dwordx4 v97, s[44:47], s101 offen offset:1024  lds
s_add_u32 s101, s101, 176128
s_cmp_eq_u32 s101, 1409024
s_cselect_b32 s101, 0, s101
v_pk_mul_f32 v[4:5], v[4:5], v[60:61]
v_pk_mul_f32 v[6:7], v[6:7], v[62:63]
v_pk_mul_f32 v[8:9], v[8:9], v[64:65]
v_pk_mul_f32 v[10:11], v[10:11], v[66:67]
v_pk_mul_f32 v[60:61], v[12:13], v[12:13]
v_pk_mul_f32 v[62:63], v[14:15], v[14:15]
v_pk_mul_f32 v[64:65], v[16:17], v[16:17]
v_pk_mul_f32 v[66:67], v[18:19], v[18:19]
s_add_u32 m0, s74, 32768
s_nop 0
buffer_load_dwordx4 v96, s[44:47], s101 offen offset:0  lds
v_pk_fma_f32 v[60:61], v[60:61], s[76:77], v[90:91]
v_pk_fma_f32 v[62:63], v[62:63], s[76:77], v[90:91]
v_pk_fma_f32 v[64:65], v[64:65], s[76:77], v[90:91]
v_pk_fma_f32 v[66:67], v[66:67], s[76:77], v[90:91]
v_pk_mul_f32 v[60:61], v[60:61], v[12:13]
v_pk_mul_f32 v[62:63], v[62:63], v[14:15]
v_pk_mul_f32 v[64:65], v[64:65], v[16:17]
v_pk_mul_f32 v[66:67], v[66:67], v[18:19]
buffer_load_dwordx4 v97, s[44:47], s101 offen offset:1024  lds
s_add_u32 s101, s101, 176128
s_cmp_eq_u32 s101, 1409024
s_cselect_b32 s101, 0, s101
v_exp_f32 v60, v60
v_exp_f32 v61, v61
v_exp_f32 v62, v62
v_exp_f32 v63, v63
v_exp_f32 v64, v64
v_exp_f32 v65, v65
v_exp_f32 v66, v66
v_exp_f32 v67, v67
s_add_u32 m0, s74, 49152
s_nop 0
buffer_load_dwordx4 v96, s[44:47], s101 offen offset:0  lds
v_pk_add_f32 v[60:61], v[60:61], s[78:79]
v_pk_add_f32 v[62:63], v[62:63], s[78:79]
v_pk_add_f32 v[64:65], v[64:65], s[78:79]
v_pk_add_f32 v[66:67], v[66:67], s[78:79]
v_rcp_f32 v60, v60
v_rcp_f32 v61, v61
v_rcp_f32 v62, v62
v_rcp_f32 v63, v63
buffer_load_dwordx4 v97, s[44:47], s101 offen offset:1024  lds
s_add_u32 s101, s101, 176128
s_cmp_eq_u32 s101, 1409024
s_cselect_b32 s101, 0, s101
v_rcp_f32 v64, v64
v_rcp_f32 v65, v65
v_rcp_f32 v66, v66
v_rcp_f32 v67, v67
v_pk_mul_f32 v[12:13], v[12:13], v[60:61]
v_pk_mul_f32 v[14:15], v[14:15], v[62:63]
v_pk_mul_f32 v[16:17], v[16:17], v[64:65]
v_pk_mul_f32 v[18:19], v[18:19], v[66:67]
s_add_u32 m0, s74, 65536
s_nop 0
buffer_load_dwordx4 v96, s[44:47], s101 offen offset:0  lds
v_pk_mul_f32 v[60:61], v[20:21], v[20:21]
v_pk_mul_f32 v[62:63], v[22:23], v[22:23]
v_pk_mul_f32 v[64:65], v[24:25], v[24:25]
v_pk_mul_f32 v[66:67], v[26:27], v[26:27]
v_pk_fma_f32 v[60:61], v[60:61], s[76:77], v[90:91]
v_pk_fma_f32 v[62:63], v[62:63], s[76:77], v[90:91]
v_pk_fma_f32 v[64:65], v[64:65], s[76:77], v[90:91]
v_pk_fma_f32 v[66:67], v[66:67], s[76:77], v[90:91]
buffer_load_dwordx4 v97, s[44:47], s101 offen offset:1024  lds
s_add_u32 s101, s101, 176128
s_cmp_eq_u32 s101, 1409024
s_cselect_b32 s101, 0, s101
v_pk_mul_f32 v[60:61], v[60:61], v[20:21]
v_pk_mul_f32 v[62:63], v[62:63], v[22:23]
v_pk_mul_f32 v[64:65], v[64:65], v[24:25]
v_pk_mul_f32 v[66:67], v[66:67], v[26:27]
v_exp_f32 v60, v60
v_exp_f32 v61, v61
v_exp_f32 v62, v62
v_exp_f32 v63, v63
s_add_u32 m0, s74, 81920
s_nop 0
buffer_load_dwordx4 v96, s[44:47], s101 offen offset:0  lds
v_exp_f32 v64, v64
v_exp_f32 v65, v65
v_exp_f32 v66, v66
v_exp_f32 v67, v67
v_pk_add_f32 v[60:61], v[60:61], s[78:79]
v_pk_add_f32 v[62:63], v[62:63], s[78:79]
v_pk_add_f32 v[64:65], v[64:65], s[78:79]
v_pk_add_f32 v[66:67], v[66:67], s[78:79]
buffer_load_dwordx4 v97, s[44:47], s101 offen offset:1024  lds
s_add_u32 s101, s101, 176128
s_cmp_eq_u32 s101, 1409024
s_cselect_b32 s101, 0, s101
v_rcp_f32 v60, v60
v_rcp_f32 v61, v61
v_rcp_f32 v62, v62
v_rcp_f32 v63, v63
v_rcp_f32 v64, v64
v_rcp_f32 v65, v65
v_rcp_f32 v66, v66
v_rcp_f32 v67, v67
v_pk_mul_f32 v[20:21], v[20:21], v[60:61]
v_pk_mul_f32 v[22:23], v[22:23], v[62:63]
v_pk_mul_f32 v[24:25], v[24:25], v[64:65]
v_pk_mul_f32 v[26:27], v[26:27], v[66:67]
v_mov_b32 v68, 0
v_mov_b32 v69, 0
v_mov_b32 v70, 0
v_mov_b32 v71, 0
v_mov_b32 v72, 0
v_mov_b32 v73, 0
v_mov_b32 v74, 0
v_mov_b32 v75, 0
s_cmp_le_u32 s13, 0
s_cbranch_scc1 if_22
v_pk_add_f32 v[68:69], v[68:69], v[4:5]
v_pk_fma_f32 v[72:73], v[4:5], v[4:5], v[72:73]
v_pk_add_f32 v[68:69], v[68:69], v[6:7]
v_pk_fma_f32 v[72:73], v[6:7], v[6:7], v[72:73]
v_pk_add_f32 v[70:71], v[70:71], v[8:9]
v_pk_fma_f32 v[74:75], v[8:9], v[8:9], v[74:75]
v_pk_add_f32 v[70:71], v[70:71], v[10:11]
v_pk_fma_f32 v[74:75], v[10:11], v[10:11], v[74:75]
if_22:
s_cmp_le_u32 s13, 1
s_cbranch_scc1 if_23
v_pk_add_f32 v[68:69], v[68:69], v[12:13]
v_pk_fma_f32 v[72:73], v[12:13], v[12:13], v[72:73]
v_pk_add_f32 v[68:69], v[68:69], v[14:15]
v_pk_fma_f32 v[72:73], v[14:15], v[14:15], v[72:73]
v_pk_add_f32 v[70:71], v[70:71], v[16:17]
v_pk_fma_f32 v[74:75], v[16:17], v[16:17], v[74:75]
v_pk_add_f32 v[70:71], v[70:71], v[18:19]
v_pk_fma_f32 v[74:75], v[18:19], v[18:19], v[74:75]
if_23:
s_cmp_le_u32 s13, 2
s_cbranch_scc1 if_24
v_pk_add_f32 v[68:69], v[68:69], v[20:21]
v_pk_fma_f32 v[72:73], v[20:21], v[20:21], v[72:73]
v_pk_add_f32 v[68:69], v[68:69], v[22:23]
v_pk_fma_f32 v[72:73], v[22:23], v[22:23], v[72:73]
v_pk_add_f32 v[70:71], v[70:71], v[24:25]
v_pk_fma_f32 v[74:75], v[24:25], v[24:25], v[74:75]
v_pk_add_f32 v[70:71], v[70:71], v[26:27]
v_pk_fma_f32 v[74:75], v[26:27], v[26:27], v[74:75]
if_24:
v_add_f32 v76, v68, v69
v_add_f32 v77, v70, v71
v_add_f32 v78, v72, v73
v_add_f32 v79, v74, v75
v_permlane32_swap_b32 v76, v77
s_nop 0
v_permlane32_swap_b32 v78, v79
v_add_f32 v76, v76, v77
v_add_f32 v78, v78, v79
s_nop 1
v_permlane16_swap_b32 v76, v78
v_add_f32 v76, v76, v78
v_lshlrev_b32 v115, 2, v0
s_lshl_b32 s60, s7, 8
s_add_u32 s60, s60, 131072
v_add_u32 v116, s60, v115
v_mov_b32 v121, v76
s_cmp_eq_u32 s8, 0
s_cbranch_scc1 if_25
ds_write_b32 v116, v76
s_waitcnt lgkmcnt(0)
if_25:
v_lshrrev_b32 v117, 4, v0
v_and_b32 v118, 15, v0
v_xor_b32 v119, v118, v117
v_lshlrev_b32 v119, 4, v119
v_lshl_add_u32 v119, v117, 12, v119
s_lshl_b32 s60, s96, 18
s_lshl_b32 s61, s7, 16
s_add_u32 s60, s60, s61
v_add_u32 v98, s60, v119
v_xor_b32 v99, 64, v98
v_add_u32 v99, 15360, v99
v_xor_b32 v100, 128, v98
v_add_u32 v100, 30720, v100
v_xor_b32 v101, 192, v98
v_add_u32 v101, 46080, v101
s_cmp_lg_u32 s8, 0
s_cbranch_scc1 g1b_26
s_waitcnt vmcnt(8)
s_barrier
s_cmp_lg_u32 s8, 0
s_cbranch_scc1 if_28
ds_read_b32 v118, v116
v_readfirstlane_b32 s64, v126
s_nop 3
s_cmp_lg_u32 s64, 0
s_cbranch_scc1 fl_29
v_mov_b32 v123, 0
s_mov_b32 s65, 0
flp_30:
buffer_load_dword v122, v123, s[92:95], 0 offen sc1
s_waitcnt vmcnt(0)
v_readfirstlane_b32 s64, v122
s_add_u32 s65, s65, 1
s_nop 2
s_cmp_ge_u32 s64, 1
s_cbranch_scc1 flpok_31
s_cmp_lt_u32 s65, 100000
s_cbranch_scc0 flpok_31
s_sleep 1
s_branch flp_30
flpok_31:
fl_29:
s_mov_b32 s4, s64
s_lshl_b32 s60, s9, 2
s_add_u32 s60, s60, s7
s_lshl_b32 s60, s60, 3
s_add_u32 s60, s60, s14
s_lshl_b32 s60, s60, 9
s_add_u32 s60, s60, 15400960
v_lshlrev_b32 v117, 3, v0
v_mov_b32 v119, s4
s_waitcnt lgkmcnt(0)
v_add_f32 v118, v118, v121
buffer_store_dwordx2 v[118:119], v117, s[48:51], s60 offen offset:0 sc1
if_28:
ds_read_b64_tr_b16 v[60:61], v105 offset:0
ds_read_b64_tr_b16 v[62:63], v105 offset:1024
ds_read_b64_tr_b16 v[64:65], v106 offset:0
ds_read_b64_tr_b16 v[66:67], v106 offset:1024
ds_read_b64_tr_b16 v[68:69], v107 offset:0
ds_read_b64_tr_b16 v[70:71], v107 offset:1024
ds_read_b64_tr_b16 v[72:73], v108 offset:0
ds_read_b64_tr_b16 v[74:75], v108 offset:1024
s_add_u32 m0, s74, 98304
s_nop 0
buffer_load_dwordx4 v96, s[44:47], s101 offen offset:0  lds
buffer_load_dwordx4 v97, s[44:47], s101 offen offset:1024  lds
s_add_u32 s101, s101, 176128
s_cmp_eq_u32 s101, 1409024
s_cselect_b32 s101, 0, s101
s_waitcnt lgkmcnt(0)
v_mfma_f32_16x16x32_bf16 v[28:31], v[60:63], a[0:3], 0
ds_read_b64_tr_b16 v[76:77], v105 offset:8192
ds_read_b64_tr_b16 v[78:79], v105 offset:9216
v_mfma_f32_16x16x32_bf16 v[32:35], v[60:63], a[64:67], 0
ds_read_b64_tr_b16 v[80:81], v106 offset:8192
ds_read_b64_tr_b16 v[82:83], v106 offset:9216
v_mfma_f32_16x16x32_bf16 v[36:39], v[64:67], a[0:3], 0
ds_read_b64_tr_b16 v[84:85], v107 offset:8192
ds_read_b64_tr_b16 v[86:87], v107 offset:9216
s_add_u32 m0, s74, 114688
s_nop 0
buffer_load_dwordx4 v96, s[44:47], s101 offen offset:0  lds
v_mfma_f32_16x16x32_bf16 v[40:43], v[64:67], a[64:67], 0
ds_read_b64_tr_b16 v[88:89], v108 offset:8192
ds_read_b64_tr_b16 v[90:91], v108 offset:9216
v_mfma_f32_16x16x32_bf16 v[44:47], v[68:71], a[0:3], 0
v_mfma_f32_16x16x32_bf16 v[48:51], v[68:71], a[64:67], 0
v_mfma_f32_16x16x32_bf16 v[52:55], v[72:75], a[0:3], 0
buffer_load_dwordx4 v97, s[44:47], s101 offen offset:1024  lds
s_add_u32 s101, s101, 176128
s_cmp_eq_u32 s101, 1409024
s_cselect_b32 s101, 0, s101
v_mfma_f32_16x16x32_bf16 v[56:59], v[72:75], a[64:67], 0
s_waitcnt lgkmcnt(0)
v_mfma_f32_16x16x32_bf16 v[28:31], v[76:79], a[4:7], v[28:31]
ds_read_b64_tr_b16 v[60:61], v105 offset:16384
ds_read_b64_tr_b16 v[62:63], v105 offset:17408
v_mfma_f32_16x16x32_bf16 v[32:35], v[76:79], a[68:71], v[32:35]
ds_read_b64_tr_b16 v[64:65], v106 offset:16384
ds_read_b64_tr_b16 v[66:67], v106 offset:17408
v_mfma_f32_16x16x32_bf16 v[36:39], v[80:83], a[4:7], v[36:39]
ds_read_b64_tr_b16 v[68:69], v107 offset:16384
ds_read_b64_tr_b16 v[70:71], v107 offset:17408
v_mfma_f32_16x16x32_bf16 v[40:43], v[80:83], a[68:71], v[40:43]
ds_read_b64_tr_b16 v[72:73], v108 offset:16384
ds_read_b64_tr_b16 v[74:75], v108 offset:17408
v_mfma_f32_16x16x32_bf16 v[44:47], v[84:87], a[4:7], v[44:47]
v_mfma_f32_16x16x32_bf16 v[48:51], v[84:87], a[68:71], v[48:51]
v_mfma_f32_16x16x32_bf16 v[52:55], v[88:91], a[4:7], v[52:55]
v_mfma_f32_16x16x32_bf16 v[56:59], v[88:91], a[68:71], v[56:59]
s_waitcnt lgkmcnt(0)
v_mfma_f32_16x16x32_bf16 v[28:31], v[60:63], a[8:11], v[28:31]
ds_read_b64_tr_b16 v[76:77], v105 offset:24576
ds_read_b64_tr_b16 v[78:79], v105 offset:25600
v_mfma_f32_16x16x32_bf16 v[32:35], v[60:63], a[72:75], v[32:35]
ds_read_b64_tr_b16 v[80:81], v106 offset:24576
ds_read_b64_tr_b16 v[82:83], v106 offset:25600
v_mfma_f32_16x16x32_bf16 v[36:39], v[64:67], a[8:11], v[36:39]
ds_read_b64_tr_b16 v[84:85], v107 offset:24576
ds_read_b64_tr_b16 v[86:87], v107 offset:25600
v_mfma_f32_16x16x32_bf16 v[40:43], v[64:67], a[72:75], v[40:43]
ds_read_b64_tr_b16 v[88:89], v108 offset:24576
ds_read_b64_tr_b16 v[90:91], v108 offset:25600
v_mfma_f32_16x16x32_bf16 v[44:47], v[68:71], a[8:11], v[44:47]
v_mfma_f32_16x16x32_bf16 v[48:51], v[68:71], a[72:75], v[48:51]
v_mfma_f32_16x16x32_bf16 v[52:55], v[72:75], a[8:11], v[52:55]
v_mfma_f32_16x16x32_bf16 v[56:59], v[72:75], a[72:75], v[56:59]
s_waitcnt lgkmcnt(0)
s_waitcnt vmcnt(9)
s_barrier
v_mfma_f32_16x16x32_bf16 v[28:31], v[76:79], a[12:15], v[28:31]
ds_read_b64_tr_b16 v[60:61], v105 offset:32768
ds_read_b64_tr_b16 v[62:63], v105 offset:33792
v_mfma_f32_16x16x32_bf16 v[32:35], v[76:79], a[76:79], v[32:35]
ds_read_b64_tr_b16 v[64:65], v106 offset:32768
ds_read_b64_tr_b16 v[66:67], v106 offset:33792
v_mfma_f32_16x16x32_bf16 v[36:39], v[80:83], a[12:15], v[36:39]
ds_read_b64_tr_b16 v[68:69], v107 offset:32768
ds_read_b64_tr_b16 v[70:71], v107 offset:33792
v_mfma_f32_16x16x32_bf16 v[40:43], v[80:83], a[76:79], v[40:43]
ds_read_b64_tr_b16 v[72:73], v108 offset:32768
ds_read_b64_tr_b16 v[74:75], v108 offset:33792
v_mfma_f32_16x16x32_bf16 v[44:47], v[84:87], a[12:15], v[44:47]
v_mfma_f32_16x16x32_bf16 v[48:51], v[84:87], a[76:79], v[48:51]
v_mfma_f32_16x16x32_bf16 v[52:55], v[88:91], a[12:15], v[52:55]
v_mfma_f32_16x16x32_bf16 v[56:59], v[88:91], a[76:79], v[56:59]
s_waitcnt lgkmcnt(0)
v_mfma_f32_16x16x32_bf16 v[28:31], v[60:63], a[16:19], v[28:31]
ds_read_b64_tr_b16 v[76:77], v105 offset:40960
ds_read_b64_tr_b16 v[78:79], v105 offset:41984
v_mfma_f32_16x16x32_bf16 v[32:35], v[60:63], a[80:83], v[32:35]
ds_read_b64_tr_b16 v[80:81], v106 offset:40960
ds_read_b64_tr_b16 v[82:83], v106 offset:41984
v_mfma_f32_16x16x32_bf16 v[36:39], v[64:67], a[16:19], v[36:39]
ds_read_b64_tr_b16 v[84:85], v107 offset:40960
ds_read_b64_tr_b16 v[86:87], v107 offset:41984
v_mfma_f32_16x16x32_bf16 v[40:43], v[64:67], a[80:83], v[40:43]
ds_read_b64_tr_b16 v[88:89], v108 offset:40960
ds_read_b64_tr_b16 v[90:91], v108 offset:41984
v_mfma_f32_16x16x32_bf16 v[44:47], v[68:71], a[16:19], v[44:47]
v_mfma_f32_16x16x32_bf16 v[48:51], v[68:71], a[80:83], v[48:51]
v_mfma_f32_16x16x32_bf16 v[52:55], v[72:75], a[16:19], v[52:55]
v_mfma_f32_16x16x32_bf16 v[56:59], v[72:75], a[80:83], v[56:59]
s_waitcnt lgkmcnt(0)
s_cmp_lg_u32 s8, 0
s_cbranch_scc1 if_32
s_mov_b32 s73, 0
v_lshlrev_b32 v3, 3, v0
s_lshl_b32 s67, s9, 2
s_add_u32 s67, s67, s7
s_lshl_b32 s67, s67, 12
s_add_u32 s67, s67, 15400960
buffer_load_dwordx2 v[92:93], v3, s[48:51], s67 offen offset:0 sc1
buffer_load_dwordx2 v[94:95], v3, s[48:51], s67 offen offset:512 sc1
buffer_load_dwordx2 v[96:97], v3, s[48:51], s67 offen offset:1024 sc1
buffer_load_dwordx2 v[98:99], v3, s[48:51], s67 offen offset:1536 sc1
buffer_load_dwordx2 v[100:101], v3, s[48:51], s67 offen offset:2048 sc1
buffer_load_dwordx2 v[102:103], v3, s[48:51], s67 offen offset:2560 sc1
buffer_load_dwordx2 v[118:119], v3, s[48:51], s67 offen offset:3072 sc1
buffer_load_dwordx2 v[120:121], v3, s[48:51], s67 offen offset:3584 sc1
if_32:
v_mfma_f32_16x16x32_bf16 v[28:31], v[76:79], a[20:23], v[28:31]
ds_read_b64_tr_b16 v[60:61], v105 offset:49152
ds_read_b64_tr_b16 v[62:63], v105 offset:50176
v_mfma_f32_16x16x32_bf16 v[32:35], v[76:79], a[84:87], v[32:35]
ds_read_b64_tr_b16 v[64:65], v106 offset:49152
ds_read_b64_tr_b16 v[66:67], v106 offset:50176
v_mfma_f32_16x16x32_bf16 v[36:39], v[80:83], a[20:23], v[36:39]
ds_read_b64_tr_b16 v[68:69], v107 offset:49152
ds_read_b64_tr_b16 v[70:71], v107 offset:50176
v_mfma_f32_16x16x32_bf16 v[40:43], v[80:83], a[84:87], v[40:43]
ds_read_b64_tr_b16 v[72:73], v108 offset:49152
ds_read_b64_tr_b16 v[74:75], v108 offset:50176
v_mfma_f32_16x16x32_bf16 v[44:47], v[84:87], a[20:23], v[44:47]
v_mfma_f32_16x16x32_bf16 v[48:51], v[84:87], a[84:87], v[48:51]
v_mfma_f32_16x16x32_bf16 v[52:55], v[88:91], a[20:23], v[52:55]
v_mfma_f32_16x16x32_bf16 v[56:59], v[88:91], a[84:87], v[56:59]
s_waitcnt lgkmcnt(0)
v_mfma_f32_16x16x32_bf16 v[28:31], v[60:63], a[24:27], v[28:31]
ds_read_b64_tr_b16 v[76:77], v105 offset:57344
ds_read_b64_tr_b16 v[78:79], v105 offset:58368
v_mfma_f32_16x16x32_bf16 v[32:35], v[60:63], a[88:91], v[32:35]
ds_read_b64_tr_b16 v[80:81], v106 offset:57344
ds_read_b64_tr_b16 v[82:83], v106 offset:58368
v_mfma_f32_16x16x32_bf16 v[36:39], v[64:67], a[24:27], v[36:39]
ds_read_b64_tr_b16 v[84:85], v107 offset:57344
ds_read_b64_tr_b16 v[86:87], v107 offset:58368
v_mfma_f32_16x16x32_bf16 v[40:43], v[64:67], a[88:91], v[40:43]
ds_read_b64_tr_b16 v[88:89], v108 offset:57344
ds_read_b64_tr_b16 v[90:91], v108 offset:58368
v_mfma_f32_16x16x32_bf16 v[44:47], v[68:71], a[24:27], v[44:47]
v_mfma_f32_16x16x32_bf16 v[48:51], v[68:71], a[88:91], v[48:51]
v_mfma_f32_16x16x32_bf16 v[52:55], v[72:75], a[24:27], v[52:55]
v_mfma_f32_16x16x32_bf16 v[56:59], v[72:75], a[88:91], v[56:59]
s_waitcnt lgkmcnt(0)
s_waitcnt vmcnt(13)
s_barrier
v_add_u32 v109, 65536, v105
v_add_u32 v110, 65536, v106
v_add_u32 v111, 65536, v107
v_add_u32 v112, 65536, v108
v_mfma_f32_16x16x32_bf16 v[28:31], v[76:79], a[28:31], v[28:31]
ds_read_b64_tr_b16 v[60:61], v109 offset:0
ds_read_b64_tr_b16 v[62:63], v109 offset:1024
v_mfma_f32_16x16x32_bf16 v[32:35], v[76:79], a[92:95], v[32:35]
ds_read_b64_tr_b16 v[64:65], v110 offset:0
ds_read_b64_tr_b16 v[66:67], v110 offset:1024
v_mfma_f32_16x16x32_bf16 v[36:39], v[80:83], a[28:31], v[36:39]
ds_read_b64_tr_b16 v[68:69], v111 offset:0
ds_read_b64_tr_b16 v[70:71], v111 offset:1024
v_mfma_f32_16x16x32_bf16 v[40:43], v[80:83], a[92:95], v[40:43]
ds_read_b64_tr_b16 v[72:73], v112 offset:0
ds_read_b64_tr_b16 v[74:75], v112 offset:1024
v_mfma_f32_16x16x32_bf16 v[44:47], v[84:87], a[28:31], v[44:47]
v_mfma_f32_16x16x32_bf16 v[48:51], v[84:87], a[92:95], v[48:51]
v_mfma_f32_16x16x32_bf16 v[52:55], v[88:91], a[28:31], v[52:55]
v_mfma_f32_16x16x32_bf16 v[56:59], v[88:91], a[92:95], v[56:59]
s_waitcnt lgkmcnt(0)
v_mfma_f32_16x16x32_bf16 v[28:31], v[60:63], a[32:35], v[28:31]
ds_read_b64_tr_b16 v[76:77], v109 offset:8192
ds_read_b64_tr_b16 v[78:79], v109 offset:9216
v_mfma_f32_16x16x32_bf16 v[32:35], v[60:63], a[96:99], v[32:35]
ds_read_b64_tr_b16 v[80:81], v110 offset:8192
ds_read_b64_tr_b16 v[82:83], v110 offset:9216
v_mfma_f32_16x16x32_bf16 v[36:39], v[64:67], a[32:35], v[36:39]
ds_read_b64_tr_b16 v[84:85], v111 offset:8192
ds_read_b64_tr_b16 v[86:87], v111 offset:9216
v_mfma_f32_16x16x32_bf16 v[40:43], v[64:67], a[96:99], v[40:43]
ds_read_b64_tr_b16 v[88:89], v112 offset:8192
ds_read_b64_tr_b16 v[90:91], v112 offset:9216
v_mfma_f32_16x16x32_bf16 v[44:47], v[68:71], a[32:35], v[44:47]
v_mfma_f32_16x16x32_bf16 v[48:51], v[68:71], a[96:99], v[48:51]
v_mfma_f32_16x16x32_bf16 v[52:55], v[72:75], a[32:35], v[52:55]
v_mfma_f32_16x16x32_bf16 v[56:59], v[72:75], a[96:99], v[56:59]
s_waitcnt lgkmcnt(0)
v_add_u32 v109, 81920, v105
v_add_u32 v110, 81920, v106
v_add_u32 v111, 81920, v107
v_add_u32 v112, 81920, v108
v_mfma_f32_16x16x32_bf16 v[28:31], v[76:79], a[36:39], v[28:31]
ds_read_b64_tr_b16 v[60:61], v109 offset:0
ds_read_b64_tr_b16 v[62:63], v109 offset:1024
v_mfma_f32_16x16x32_bf16 v[32:35], v[76:79], a[100:103], v[32:35]
ds_read_b64_tr_b16 v[64:65], v110 offset:0
ds_read_b64_tr_b16 v[66:67], v110 offset:1024
v_mfma_f32_16x16x32_bf16 v[36:39], v[80:83], a[36:39], v[36:39]
ds_read_b64_tr_b16 v[68:69], v111 offset:0
ds_read_b64_tr_b16 v[70:71], v111 offset:1024
v_mfma_f32_16x16x32_bf16 v[40:43], v[80:83], a[100:103], v[40:43]
ds_read_b64_tr_b16 v[72:73], v112 offset:0
ds_read_b64_tr_b16 v[74:75], v112 offset:1024
v_mfma_f32_16x16x32_bf16 v[44:47], v[84:87], a[36:39], v[44:47]
v_mfma_f32_16x16x32_bf16 v[48:51], v[84:87], a[100:103], v[48:51]
v_mfma_f32_16x16x32_bf16 v[52:55], v[88:91], a[36:39], v[52:55]
v_mfma_f32_16x16x32_bf16 v[56:59], v[88:91], a[100:103], v[56:59]
s_waitcnt lgkmcnt(0)
v_mfma_f32_16x16x32_bf16 v[28:31], v[60:63], a[40:43], v[28:31]
ds_read_b64_tr_b16 v[76:77], v109 offset:8192
ds_read_b64_tr_b16 v[78:79], v109 offset:9216
v_mfma_f32_16x16x32_bf16 v[32:35], v[60:63], a[104:107], v[32:35]
ds_read_b64_tr_b16 v[80:81], v110 offset:8192
ds_read_b64_tr_b16 v[82:83], v110 offset:9216
v_mfma_f32_16x16x32_bf16 v[36:39], v[64:67], a[40:43], v[36:39]
ds_read_b64_tr_b16 v[84:85], v111 offset:8192
ds_read_b64_tr_b16 v[86:87], v111 offset:9216
v_mfma_f32_16x16x32_bf16 v[40:43], v[64:67], a[104:107], v[40:43]
ds_read_b64_tr_b16 v[88:89], v112 offset:8192
ds_read_b64_tr_b16 v[90:91], v112 offset:9216
v_mfma_f32_16x16x32_bf16 v[44:47], v[68:71], a[40:43], v[44:47]
v_mfma_f32_16x16x32_bf16 v[48:51], v[68:71], a[104:107], v[48:51]
v_mfma_f32_16x16x32_bf16 v[52:55], v[72:75], a[40:43], v[52:55]
v_mfma_f32_16x16x32_bf16 v[56:59], v[72:75], a[104:107], v[56:59]
s_waitcnt lgkmcnt(0)
s_waitcnt vmcnt(8)
s_barrier
s_cmp_lg_u32 s8, 0
s_cbranch_scc1 if_33
s_cmp_lg_u32 s73, 0
s_cbranch_scc1 sr_34
s_waitcnt vmcnt(0)
v_xor_b32 v2, s4, v93
v_xor_b32 v95, s4, v95
v_or_b32 v2, v2, v95
v_xor_b32 v97, s4, v97
v_or_b32 v2, v2, v97
v_xor_b32 v99, s4, v99
v_or_b32 v2, v2, v99
v_xor_b32 v101, s4, v101
v_or_b32 v2, v2, v101
v_xor_b32 v103, s4, v103
v_or_b32 v2, v2, v103
v_xor_b32 v119, s4, v119
v_or_b32 v2, v2, v119
v_xor_b32 v121, s4, v121
v_or_b32 v2, v2, v121
v_cmp_ne_u32 vcc, 0, v2
s_nop 4
s_cbranch_vccnz srn_35
s_mov_b32 s73, 1
s_branch sr_34
srn_35:
v_lshlrev_b32 v3, 3, v0
s_lshl_b32 s67, s9, 2
s_add_u32 s67, s67, s7
s_lshl_b32 s67, s67, 12
s_add_u32 s67, s67, 15400960
buffer_load_dwordx2 v[92:93], v3, s[48:51], s67 offen offset:0 sc1
buffer_load_dwordx2 v[94:95], v3, s[48:51], s67 offen offset:512 sc1
buffer_load_dwordx2 v[96:97], v3, s[48:51], s67 offen offset:1024 sc1
buffer_load_dwordx2 v[98:99], v3, s[48:51], s67 offen offset:1536 sc1
buffer_load_dwordx2 v[100:101], v3, s[48:51], s67 offen offset:2048 sc1
buffer_load_dwordx2 v[102:103], v3, s[48:51], s67 offen offset:2560 sc1
buffer_load_dwordx2 v[118:119], v3, s[48:51], s67 offen offset:3072 sc1
buffer_load_dwordx2 v[120:121], v3, s[48:51], s67 offen offset:3584 sc1
sr_34:
if_33:
v_add_u32 v109, 98304, v105
v_add_u32 v110, 98304, v106
v_add_u32 v111, 98304, v107
v_add_u32 v112, 98304, v108
v_mfma_f32_16x16x32_bf16 v[28:31], v[76:79], a[44:47], v[28:31]
ds_read_b64_tr_b16 v[60:61], v109 offset:0
ds_read_b64_tr_b16 v[62:63], v109 offset:1024
v_mfma_f32_16x16x32_bf16 v[32:35], v[76:79], a[108:111], v[32:35]
ds_read_b64_tr_b16 v[64:65], v110 offset:0
ds_read_b64_tr_b16 v[66:67], v110 offset:1024
v_mfma_f32_16x16x32_bf16 v[36:39], v[80:83], a[44:47], v[36:39]
ds_read_b64_tr_b16 v[68:69], v111 offset:0
ds_read_b64_tr_b16 v[70:71], v111 offset:1024
v_mfma_f32_16x16x32_bf16 v[40:43], v[80:83], a[108:111], v[40:43]
ds_read_b64_tr_b16 v[72:73], v112 offset:0
ds_read_b64_tr_b16 v[74:75], v112 offset:1024
v_mfma_f32_16x16x32_bf16 v[44:47], v[84:87], a[44:47], v[44:47]
v_mfma_f32_16x16x32_bf16 v[48:51], v[84:87], a[108:111], v[48:51]
v_mfma_f32_16x16x32_bf16 v[52:55], v[88:91], a[44:47], v[52:55]
v_mfma_f32_16x16x32_bf16 v[56:59], v[88:91], a[108:111], v[56:59]
s_waitcnt lgkmcnt(0)
v_mfma_f32_16x16x32_bf16 v[28:31], v[60:63], a[48:51], v[28:31]
ds_read_b64_tr_b16 v[76:77], v109 offset:8192
ds_read_b64_tr_b16 v[78:79], v109 offset:9216
v_mfma_f32_16x16x32_bf16 v[32:35], v[60:63], a[112:115], v[32:35]
ds_read_b64_tr_b16 v[80:81], v110 offset:8192
ds_read_b64_tr_b16 v[82:83], v110 offset:9216
v_mfma_f32_16x16x32_bf16 v[36:39], v[64:67], a[48:51], v[36:39]
ds_read_b64_tr_b16 v[84:85], v111 offset:8192
ds_read_b64_tr_b16 v[86:87], v111 offset:9216
v_mfma_f32_16x16x32_bf16 v[40:43], v[64:67], a[112:115], v[40:43]
ds_read_b64_tr_b16 v[88:89], v112 offset:8192
ds_read_b64_tr_b16 v[90:91], v112 offset:9216
v_mfma_f32_16x16x32_bf16 v[44:47], v[68:71], a[48:51], v[44:47]
v_mfma_f32_16x16x32_bf16 v[48:51], v[68:71], a[112:115], v[48:51]
v_mfma_f32_16x16x32_bf16 v[52:55], v[72:75], a[48:51], v[52:55]
v_mfma_f32_16x16x32_bf16 v[56:59], v[72:75], a[112:115], v[56:59]
s_waitcnt lgkmcnt(0)
v_add_u32 v109, 114688, v105
v_add_u32 v110, 114688, v106
v_add_u32 v111, 114688, v107
v_add_u32 v112, 114688, v108
v_mfma_f32_16x16x32_bf16 v[28:31], v[76:79], a[52:55], v[28:31]
ds_read_b64_tr_b16 v[60:61], v109 offset:0
ds_read_b64_tr_b16 v[62:63], v109 offset:1024
v_mfma_f32_16x16x32_bf16 v[32:35], v[76:79], a[116:119], v[32:35]
ds_read_b64_tr_b16 v[64:65], v110 offset:0
ds_read_b64_tr_b16 v[66:67], v110 offset:1024
v_mfma_f32_16x16x32_bf16 v[36:39], v[80:83], a[52:55], v[36:39]
ds_read_b64_tr_b16 v[68:69], v111 offset:0
ds_read_b64_tr_b16 v[70:71], v111 offset:1024
v_mfma_f32_16x16x32_bf16 v[40:43], v[80:83], a[116:119], v[40:43]
ds_read_b64_tr_b16 v[72:73], v112 offset:0
ds_read_b64_tr_b16 v[74:75], v112 offset:1024
v_mfma_f32_16x16x32_bf16 v[44:47], v[84:87], a[52:55], v[44:47]
v_mfma_f32_16x16x32_bf16 v[48:51], v[84:87], a[116:119], v[48:51]
v_mfma_f32_16x16x32_bf16 v[52:55], v[88:91], a[52:55], v[52:55]
v_mfma_f32_16x16x32_bf16 v[56:59], v[88:91], a[116:119], v[56:59]
s_waitcnt lgkmcnt(0)
v_mfma_f32_16x16x32_bf16 v[28:31], v[60:63], a[56:59], v[28:31]
ds_read_b64_tr_b16 v[76:77], v109 offset:8192
ds_read_b64_tr_b16 v[78:79], v109 offset:9216
v_mfma_f32_16x16x32_bf16 v[32:35], v[60:63], a[120:123], v[32:35]
ds_read_b64_tr_b16 v[80:81], v110 offset:8192
ds_read_b64_tr_b16 v[82:83], v110 offset:9216
v_mfma_f32_16x16x32_bf16 v[36:39], v[64:67], a[56:59], v[36:39]
ds_read_b64_tr_b16 v[84:85], v111 offset:8192
ds_read_b64_tr_b16 v[86:87], v111 offset:9216
v_mfma_f32_16x16x32_bf16 v[40:43], v[64:67], a[120:123], v[40:43]
ds_read_b64_tr_b16 v[88:89], v112 offset:8192
ds_read_b64_tr_b16 v[90:91], v112 offset:9216
v_mfma_f32_16x16x32_bf16 v[44:47], v[68:71], a[56:59], v[44:47]
v_mfma_f32_16x16x32_bf16 v[48:51], v[68:71], a[120:123], v[48:51]
v_mfma_f32_16x16x32_bf16 v[52:55], v[72:75], a[56:59], v[52:55]
v_mfma_f32_16x16x32_bf16 v[56:59], v[72:75], a[120:123], v[56:59]
s_waitcnt lgkmcnt(0)
v_mfma_f32_16x16x32_bf16 v[28:31], v[76:79], a[60:63], v[28:31]
v_mfma_f32_16x16x32_bf16 v[32:35], v[76:79], a[124:127], v[32:35]
v_mfma_f32_16x16x32_bf16 v[36:39], v[80:83], a[60:63], v[36:39]
v_mfma_f32_16x16x32_bf16 v[40:43], v[80:83], a[124:127], v[40:43]
v_mfma_f32_16x16x32_bf16 v[44:47], v[84:87], a[60:63], v[44:47]
v_mfma_f32_16x16x32_bf16 v[48:51], v[84:87], a[124:127], v[48:51]
v_mfma_f32_16x16x32_bf16 v[52:55], v[88:91], a[60:63], v[52:55]
v_mfma_f32_16x16x32_bf16 v[56:59], v[88:91], a[124:127], v[56:59]
s_branch g1j_27
g1b_26:
s_waitcnt vmcnt(8)
s_barrier
s_cmp_lg_u32 s8, 0
s_cbranch_scc1 if_36
ds_read_b32 v118, v116
v_readfirstlane_b32 s64, v126
s_nop 3
s_cmp_lg_u32 s64, 0
s_cbranch_scc1 fl_37
v_mov_b32 v123, 0
s_mov_b32 s65, 0
flp_38:
buffer_load_dword v122, v123, s[92:95], 0 offen sc1
s_waitcnt vmcnt(0)
v_readfirstlane_b32 s64, v122
s_add_u32 s65, s65, 1
s_nop 2
s_cmp_ge_u32 s64, 1
s_cbranch_scc1 flpok_39
s_cmp_lt_u32 s65, 100000
s_cbranch_scc0 flpok_39
s_sleep 1
s_branch flp_38
flpok_39:
fl_37:
s_mov_b32 s4, s64
s_lshl_b32 s60, s9, 2
s_add_u32 s60, s60, s7
s_lshl_b32 s60, s60, 3
s_add_u32 s60, s60, s14
s_lshl_b32 s60, s60, 9
s_add_u32 s60, s60, 15400960
v_lshlrev_b32 v117, 3, v0
v_mov_b32 v119, s4
s_waitcnt lgkmcnt(0)
v_add_f32 v118, v118, v121
buffer_store_dwordx2 v[118:119], v117, s[48:51], s60 offen offset:0 sc1
if_36:
ds_read_b64_tr_b16 v[60:61], v105 offset:0
ds_read_b64_tr_b16 v[62:63], v105 offset:1024
ds_read_b64_tr_b16 v[64:65], v106 offset:0
ds_read_b64_tr_b16 v[66:67], v106 offset:1024
s_add_u32 m0, s74, 98304
s_nop 0
buffer_load_dwordx4 v96, s[44:47], s101 offen offset:0  lds
buffer_load_dwordx4 v97, s[44:47], s101 offen offset:1024  lds
s_add_u32 s101, s101, 176128
s_cmp_eq_u32 s101, 1409024
s_cselect_b32 s101, 0, s101
s_waitcnt lgkmcnt(0)
v_mfma_f32_16x16x32_bf16 v[28:31], v[60:63], a[0:3], 0
ds_read_b64_tr_b16 v[76:77], v105 offset:8192
ds_read_b64_tr_b16 v[78:79], v105 offset:9216
v_mfma_f32_16x16x32_bf16 v[32:35], v[60:63], a[64:67], 0
ds_read_b64_tr_b16 v[80:81], v106 offset:8192
ds_read_b64_tr_b16 v[82:83], v106 offset:9216
s_add_u32 m0, s74, 114688
s_nop 0
buffer_load_dwordx4 v96, s[44:47], s101 offen offset:0  lds
v_mfma_f32_16x16x32_bf16 v[36:39], v[64:67], a[0:3], 0
v_mfma_f32_16x16x32_bf16 v[40:43], v[64:67], a[64:67], 0
buffer_load_dwordx4 v97, s[44:47], s101 offen offset:1024  lds
s_add_u32 s101, s101, 176128
s_cmp_eq_u32 s101, 1409024
s_cselect_b32 s101, 0, s101
s_waitcnt lgkmcnt(0)
v_mfma_f32_16x16x32_bf16 v[28:31], v[76:79], a[4:7], v[28:31]
ds_read_b64_tr_b16 v[60:61], v105 offset:16384
ds_read_b64_tr_b16 v[62:63], v105 offset:17408
v_mfma_f32_16x16x32_bf16 v[32:35], v[76:79], a[68:71], v[32:35]
ds_read_b64_tr_b16 v[64:65], v106 offset:16384
ds_read_b64_tr_b16 v[66:67], v106 offset:17408
v_mfma_f32_16x16x32_bf16 v[36:39], v[80:83], a[4:7], v[36:39]
v_mfma_f32_16x16x32_bf16 v[40:43], v[80:83], a[68:71], v[40:43]
s_waitcnt lgkmcnt(0)
v_mfma_f32_16x16x32_bf16 v[28:31], v[60:63], a[8:11], v[28:31]
ds_read_b64_tr_b16 v[76:77], v105 offset:24576
ds_read_b64_tr_b16 v[78:79], v105 offset:25600
v_mfma_f32_16x16x32_bf16 v[32:35], v[60:63], a[72:75], v[32:35]
ds_read_b64_tr_b16 v[80:81], v106 offset:24576
ds_read_b64_tr_b16 v[82:83], v106 offset:25600
v_mfma_f32_16x16x32_bf16 v[36:39], v[64:67], a[8:11], v[36:39]
v_mfma_f32_16x16x32_bf16 v[40:43], v[64:67], a[72:75], v[40:43]
s_waitcnt lgkmcnt(0)
s_waitcnt vmcnt(8)
s_barrier
v_mfma_f32_16x16x32_bf16 v[28:31], v[76:79], a[12:15], v[28:31]
ds_read_b64_tr_b16 v[60:61], v105 offset:32768
ds_read_b64_tr_b16 v[62:63], v105 offset:33792
s_lshl_b32 m0, s7, 12
s_add_u32 m0, m0, 0
s_add_u32 s3, s5, 0
s_and_b32 s3, s3, 3
s_lshl_b32 s3, s3, 8
buffer_load_dwordx4 v98, s[52:55], s3 offen offset:0  lds
v_mfma_f32_16x16x32_bf16 v[32:35], v[76:79], a[76:79], v[32:35]
ds_read_b64_tr_b16 v[64:65], v106 offset:32768
ds_read_b64_tr_b16 v[66:67], v106 offset:33792
buffer_load_dwordx4 v99, s[52:55], s3 offen offset:1024  lds
v_mfma_f32_16x16x32_bf16 v[36:39], v[80:83], a[12:15], v[36:39]
buffer_load_dwordx4 v100, s[52:55], s3 offen offset:2048  lds
v_mfma_f32_16x16x32_bf16 v[40:43], v[80:83], a[76:79], v[40:43]
buffer_load_dwordx4 v101, s[52:55], s3 offen offset:3072  lds
s_waitcnt lgkmcnt(0)
v_mfma_f32_16x16x32_bf16 v[28:31], v[60:63], a[16:19], v[28:31]
ds_read_b64_tr_b16 v[76:77], v105 offset:40960
ds_read_b64_tr_b16 v[78:79], v105 offset:41984
s_lshl_b32 m0, s7, 12
s_add_u32 m0, m0, 16384
s_add_u32 s3, s5, 0
s_and_b32 s3, s3, 3
s_lshl_b32 s3, s3, 8
s_add_u32 s3, s3, 1024
buffer_load_dwordx4 v98, s[52:55], s3 offen offset:0  lds
v_mfma_f32_16x16x32_bf16 v[32:35], v[60:63], a[80:83], v[32:35]
ds_read_b64_tr_b16 v[80:81], v106 offset:40960
ds_read_b64_tr_b16 v[82:83], v106 offset:41984
buffer_load_dwordx4 v99, s[52:55], s3 offen offset:1024  lds
v_mfma_f32_16x16x32_bf16 v[36:39], v[64:67], a[16:19], v[36:39]
buffer_load_dwordx4 v100, s[52:55], s3 offen offset:2048  lds
v_mfma_f32_16x16x32_bf16 v[40:43], v[64:67], a[80:83], v[40:43]
buffer_load_dwordx4 v101, s[52:55], s3 offen offset:3072  lds
s_waitcnt lgkmcnt(0)
s_cmp_lg_u32 s8, 0
s_cbranch_scc1 if_40
s_mov_b32 s73, 0
v_lshlrev_b32 v3, 3, v0
s_lshl_b32 s67, s9, 2
s_add_u32 s67, s67, s7
s_lshl_b32 s67, s67, 12
s_add_u32 s67, s67, 15400960
buffer_load_dwordx2 v[92:93], v3, s[48:51], s67 offen offset:0 sc1
buffer_load_dwordx2 v[94:95], v3, s[48:51], s67 offen offset:512 sc1
buffer_load_dwordx2 v[96:97], v3, s[48:51], s67 offen offset:1024 sc1
buffer_load_dwordx2 v[98:99], v3, s[48:51], s67 offen offset:1536 sc1
buffer_load_dwordx2 v[100:101], v3, s[48:51], s67 offen offset:2048 sc1
buffer_load_dwordx2 v[102:103], v3, s[48:51], s67 offen offset:2560 sc1
buffer_load_dwordx2 v[118:119], v3, s[48:51], s67 offen offset:3072 sc1
buffer_load_dwordx2 v[120:121], v3, s[48:51], s67 offen offset:3584 sc1
if_40:
v_mfma_f32_16x16x32_bf16 v[28:31], v[76:79], a[20:23], v[28:31]
ds_read_b64_tr_b16 v[60:61], v105 offset:49152
ds_read_b64_tr_b16 v[62:63], v105 offset:50176
v_mfma_f32_16x16x32_bf16 v[32:35], v[76:79], a[84:87], v[32:35]
ds_read_b64_tr_b16 v[64:65], v106 offset:49152
ds_read_b64_tr_b16 v[66:67], v106 offset:50176
v_mfma_f32_16x16x32_bf16 v[36:39], v[80:83], a[20:23], v[36:39]
v_mfma_f32_16x16x32_bf16 v[40:43], v[80:83], a[84:87], v[40:43]
s_waitcnt lgkmcnt(0)
v_mfma_f32_16x16x32_bf16 v[28:31], v[60:63], a[24:27], v[28:31]
ds_read_b64_tr_b16 v[76:77], v105 offset:57344
ds_read_b64_tr_b16 v[78:79], v105 offset:58368
v_mfma_f32_16x16x32_bf16 v[32:35], v[60:63], a[88:91], v[32:35]
ds_read_b64_tr_b16 v[80:81], v106 offset:57344
ds_read_b64_tr_b16 v[82:83], v106 offset:58368
v_mfma_f32_16x16x32_bf16 v[36:39], v[64:67], a[24:27], v[36:39]
v_mfma_f32_16x16x32_bf16 v[40:43], v[64:67], a[88:91], v[40:43]
s_waitcnt lgkmcnt(0)
s_waitcnt vmcnt(12)
s_barrier
v_add_u32 v109, 65536, v105
v_add_u32 v110, 65536, v106
v_mfma_f32_16x16x32_bf16 v[28:31], v[76:79], a[28:31], v[28:31]
ds_read_b64_tr_b16 v[60:61], v109 offset:0
ds_read_b64_tr_b16 v[62:63], v109 offset:1024
s_lshl_b32 m0, s7, 12
s_add_u32 m0, m0, 32768
s_add_u32 s3, s5, 0
s_and_b32 s3, s3, 3
s_lshl_b32 s3, s3, 8
s_add_u32 s3, s3, 2048
buffer_load_dwordx4 v98, s[52:55], s3 offen offset:0  lds
v_mfma_f32_16x16x32_bf16 v[32:35], v[76:79], a[92:95], v[32:35]
ds_read_b64_tr_b16 v[64:65], v110 offset:0
ds_read_b64_tr_b16 v[66:67], v110 offset:1024
buffer_load_dwordx4 v99, s[52:55], s3 offen offset:1024  lds
v_mfma_f32_16x16x32_bf16 v[36:39], v[80:83], a[28:31], v[36:39]
buffer_load_dwordx4 v100, s[52:55], s3 offen offset:2048  lds
v_mfma_f32_16x16x32_bf16 v[40:43], v[80:83], a[92:95], v[40:43]
buffer_load_dwordx4 v101, s[52:55], s3 offen offset:3072  lds
s_waitcnt lgkmcnt(0)
v_mfma_f32_16x16x32_bf16 v[28:31], v[60:63], a[32:35], v[28:31]
ds_read_b64_tr_b16 v[76:77], v109 offset:8192
ds_read_b64_tr_b16 v[78:79], v109 offset:9216
s_lshl_b32 m0, s7, 12
s_add_u32 m0, m0, 49152
s_add_u32 s3, s5, 0
s_and_b32 s3, s3, 3
s_lshl_b32 s3, s3, 8
s_add_u32 s3, s3, 3072
buffer_load_dwordx4 v98, s[52:55], s3 offen offset:0  lds
v_mfma_f32_16x16x32_bf16 v[32:35], v[60:63], a[96:99], v[32:35]
ds_read_b64_tr_b16 v[80:81], v110 offset:8192
ds_read_b64_tr_b16 v[82:83], v110 offset:9216
buffer_load_dwordx4 v99, s[52:55], s3 offen offset:1024  lds
v_mfma_f32_16x16x32_bf16 v[36:39], v[64:67], a[32:35], v[36:39]
buffer_load_dwordx4 v100, s[52:55], s3 offen offset:2048  lds
v_mfma_f32_16x16x32_bf16 v[40:43], v[64:67], a[96:99], v[40:43]
buffer_load_dwordx4 v101, s[52:55], s3 offen offset:3072  lds
s_waitcnt lgkmcnt(0)
v_add_u32 v109, 81920, v105
v_add_u32 v110, 81920, v106
v_mfma_f32_16x16x32_bf16 v[28:31], v[76:79], a[36:39], v[28:31]
ds_read_b64_tr_b16 v[60:61], v109 offset:0
ds_read_b64_tr_b16 v[62:63], v109 offset:1024
v_mfma_f32_16x16x32_bf16 v[32:35], v[76:79], a[100:103], v[32:35]
ds_read_b64_tr_b16 v[64:65], v110 offset:0
ds_read_b64_tr_b16 v[66:67], v110 offset:1024
v_mfma_f32_16x16x32_bf16 v[36:39], v[80:83], a[36:39], v[36:39]
v_mfma_f32_16x16x32_bf16 v[40:43], v[80:83], a[100:103], v[40:43]
s_waitcnt lgkmcnt(0)
v_mfma_f32_16x16x32_bf16 v[28:31], v[60:63], a[40:43], v[28:31]
ds_read_b64_tr_b16 v[76:77], v109 offset:8192
ds_read_b64_tr_b16 v[78:79], v109 offset:9216
v_mfma_f32_16x16x32_bf16 v[32:35], v[60:63], a[104:107], v[32:35]
ds_read_b64_tr_b16 v[80:81], v110 offset:8192
ds_read_b64_tr_b16 v[82:83], v110 offset:9216
v_mfma_f32_16x16x32_bf16 v[36:39], v[64:67], a[40:43], v[36:39]
v_mfma_f32_16x16x32_bf16 v[40:43], v[64:67], a[104:107], v[40:43]
s_waitcnt lgkmcnt(0)
s_waitcnt vmcnt(16)
s_barrier
s_cmp_lg_u32 s8, 0
s_cbranch_scc1 if_41
s_cmp_lg_u32 s73, 0
s_cbranch_scc1 sr_42
s_waitcnt vmcnt(0)
v_xor_b32 v2, s4, v93
v_xor_b32 v95, s4, v95
v_or_b32 v2, v2, v95
v_xor_b32 v97, s4, v97
v_or_b32 v2, v2, v97
v_xor_b32 v99, s4, v99
v_or_b32 v2, v2, v99
v_xor_b32 v101, s4, v101
v_or_b32 v2, v2, v101
v_xor_b32 v103, s4, v103
v_or_b32 v2, v2, v103
v_xor_b32 v119, s4, v119
v_or_b32 v2, v2, v119
v_xor_b32 v121, s4, v121
v_or_b32 v2, v2, v121
v_cmp_ne_u32 vcc, 0, v2
s_nop 4
s_cbranch_vccnz srn_43
s_mov_b32 s73, 1
s_branch sr_42
srn_43:
v_lshlrev_b32 v3, 3, v0
s_lshl_b32 s67, s9, 2
s_add_u32 s67, s67, s7
s_lshl_b32 s67, s67, 12
s_add_u32 s67, s67, 15400960
buffer_load_dwordx2 v[92:93], v3, s[48:51], s67 offen offset:0 sc1
buffer_load_dwordx2 v[94:95], v3, s[48:51], s67 offen offset:512 sc1
buffer_load_dwordx2 v[96:97], v3, s[48:51], s67 offen offset:1024 sc1
buffer_load_dwordx2 v[98:99], v3, s[48:51], s67 offen offset:1536 sc1
buffer_load_dwordx2 v[100:101], v3, s[48:51], s67 offen offset:2048 sc1
buffer_load_dwordx2 v[102:103], v3, s[48:51], s67 offen offset:2560 sc1
buffer_load_dwordx2 v[118:119], v3, s[48:51], s67 offen offset:3072 sc1
buffer_load_dwordx2 v[120:121], v3, s[48:51], s67 offen offset:3584 sc1
sr_42:
if_41:
v_add_u32 v109, 98304, v105
v_add_u32 v110, 98304, v106
v_mfma_f32_16x16x32_bf16 v[28:31], v[76:79], a[44:47], v[28:31]
ds_read_b64_tr_b16 v[60:61], v109 offset:0
ds_read_b64_tr_b16 v[62:63], v109 offset:1024
s_lshl_b32 m0, s7, 12
s_add_u32 m0, m0, 65536
s_add_u32 s3, s5, 1
s_and_b32 s3, s3, 3
s_lshl_b32 s3, s3, 8
buffer_load_dwordx4 v98, s[52:55], s3 offen offset:0  lds
v_mfma_f32_16x16x32_bf16 v[32:35], v[76:79], a[108:111], v[32:35]
ds_read_b64_tr_b16 v[64:65], v110 offset:0
ds_read_b64_tr_b16 v[66:67], v110 offset:1024
buffer_load_dwordx4 v99, s[52:55], s3 offen offset:1024  lds
v_mfma_f32_16x16x32_bf16 v[36:39], v[80:83], a[44:47], v[36:39]
buffer_load_dwordx4 v100, s[52:55], s3 offen offset:2048  lds
v_mfma_f32_16x16x32_bf16 v[40:43], v[80:83], a[108:111], v[40:43]
buffer_load_dwordx4 v101, s[52:55], s3 offen offset:3072  lds
s_waitcnt lgkmcnt(0)
v_mfma_f32_16x16x32_bf16 v[28:31], v[60:63], a[48:51], v[28:31]
ds_read_b64_tr_b16 v[76:77], v109 offset:8192
ds_read_b64_tr_b16 v[78:79], v109 offset:9216
s_lshl_b32 m0, s7, 12
s_add_u32 m0, m0, 81920
s_add_u32 s3, s5, 1
s_and_b32 s3, s3, 3
s_lshl_b32 s3, s3, 8
s_add_u32 s3, s3, 1024
buffer_load_dwordx4 v98, s[52:55], s3 offen offset:0  lds
v_mfma_f32_16x16x32_bf16 v[32:35], v[60:63], a[112:115], v[32:35]
ds_read_b64_tr_b16 v[80:81], v110 offset:8192
ds_read_b64_tr_b16 v[82:83], v110 offset:9216
buffer_load_dwordx4 v99, s[52:55], s3 offen offset:1024  lds
v_mfma_f32_16x16x32_bf16 v[36:39], v[64:67], a[48:51], v[36:39]
buffer_load_dwordx4 v100, s[52:55], s3 offen offset:2048  lds
v_mfma_f32_16x16x32_bf16 v[40:43], v[64:67], a[112:115], v[40:43]
buffer_load_dwordx4 v101, s[52:55], s3 offen offset:3072  lds
s_waitcnt lgkmcnt(0)
v_add_u32 v109, 114688, v105
v_add_u32 v110, 114688, v106
v_mfma_f32_16x16x32_bf16 v[28:31], v[76:79], a[52:55], v[28:31]
ds_read_b64_tr_b16 v[60:61], v109 offset:0
ds_read_b64_tr_b16 v[62:63], v109 offset:1024
v_mfma_f32_16x16x32_bf16 v[32:35], v[76:79], a[116:119], v[32:35]
ds_read_b64_tr_b16 v[64:65], v110 offset:0
ds_read_b64_tr_b16 v[66:67], v110 offset:1024
v_mfma_f32_16x16x32_bf16 v[36:39], v[80:83], a[52:55], v[36:39]
v_mfma_f32_16x16x32_bf16 v[40:43], v[80:83], a[116:119], v[40:43]
s_waitcnt lgkmcnt(0)
v_mfma_f32_16x16x32_bf16 v[28:31], v[60:63], a[56:59], v[28:31]
ds_read_b64_tr_b16 v[76:77], v109 offset:8192
ds_read_b64_tr_b16 v[78:79], v109 offset:9216
v_mfma_f32_16x16x32_bf16 v[32:35], v[60:63], a[120:123], v[32:35]
ds_read_b64_tr_b16 v[80:81], v110 offset:8192
ds_read_b64_tr_b16 v[82:83], v110 offset:9216
v_mfma_f32_16x16x32_bf16 v[36:39], v[64:67], a[56:59], v[36:39]
v_mfma_f32_16x16x32_bf16 v[40:43], v[64:67], a[120:123], v[40:43]
s_waitcnt lgkmcnt(0)
v_mfma_f32_16x16x32_bf16 v[28:31], v[76:79], a[60:63], v[28:31]
v_mfma_f32_16x16x32_bf16 v[32:35], v[76:79], a[124:127], v[32:35]
v_mfma_f32_16x16x32_bf16 v[36:39], v[80:83], a[60:63], v[36:39]
v_mfma_f32_16x16x32_bf16 v[40:43], v[80:83], a[124:127], v[40:43]
g1j_27:
s_cmp_lg_u32 s14, 7
s_cbranch_scc1 gate_44
s_cmp_eq_u32 s8, 0
s_cbranch_scc1 gate_44
s_mov_b32 s56, s32
s_and_b32 s57, s33, 0xffff
s_mov_b32 s58, 0x400
s_mov_b32 s59, 0x00020000
v_and_b32 v122, 0x30, v0
s_lshl_b32 s60, s15, 1
s_add_u32 s60, s60, 0
s_and_b32 s60, s60, 15
s_lshl_b32 s60, s60, 6
buffer_load_dwordx4 v[60:63], v122, s[56:59], s60 offen
s_lshl_b32 s60, s15, 1
s_add_u32 s60, s60, 1
s_and_b32 s60, s60, 15
s_lshl_b32 s60, s60, 6
buffer_load_dwordx4 v[64:67], v122, s[56:59], s60 offen
s_lshl_b32 s60, s15, 1
s_add_u32 s60, s60, 2
s_and_b32 s60, s60, 15
s_lshl_b32 s60, s60, 6
buffer_load_dwordx4 v[68:71], v122, s[56:59], s60 offen
s_lshl_b32 s60, s15, 1
s_add_u32 s60, s60, 3
s_and_b32 s60, s60, 15
s_lshl_b32 s60, s60, 6
buffer_load_dwordx4 v[72:75], v122, s[56:59], s60 offen
s_lshl_b32 s60, s15, 1
s_add_u32 s60, s60, 4
s_and_b32 s60, s60, 15
s_lshl_b32 s60, s60, 6
buffer_load_dwordx4 v[76:79], v122, s[56:59], s60 offen
s_lshl_b32 s60, s15, 1
s_add_u32 s60, s60, 5
s_and_b32 s60, s60, 15
s_lshl_b32 s60, s60, 6
buffer_load_dwordx4 v[80:83], v122, s[56:59], s60 offen
s_lshl_b32 s60, s15, 1
s_add_u32 s60, s60, 6
s_and_b32 s60, s60, 15
s_lshl_b32 s60, s60, 6
buffer_load_dwordx4 v[84:87], v122, s[56:59], s60 offen
s_lshl_b32 s60, s15, 1
s_add_u32 s60, s60, 7
s_and_b32 s60, s60, 15
s_lshl_b32 s60, s60, 6
buffer_load_dwordx4 v[88:91], v122, s[56:59], s60 offen
s_waitcnt vmcnt(0)
v_mfma_f32_16x16x32_bf16 v[4:7], a[0:3], v[60:63], 0
v_mfma_f32_16x16x32_bf16 v[8:11], a[64:67], v[60:63], 0
v_mfma_f32_16x16x32_bf16 v[4:7], a[4:7], v[64:67], v[4:7]
v_mfma_f32_16x16x32_bf16 v[8:11], a[68:71], v[64:67], v[8:11]
v_mfma_f32_16x16x32_bf16 v[4:7], a[8:11], v[68:71], v[4:7]
v_mfma_f32_16x16x32_bf16 v[8:11], a[72:75], v[68:71], v[8:11]
v_mfma_f32_16x16x32_bf16 v[4:7], a[12:15], v[72:75], v[4:7]
v_mfma_f32_16x16x32_bf16 v[8:11], a[76:79], v[72:75], v[8:11]
v_mfma_f32_16x16x32_bf16 v[4:7], a[16:19], v[76:79], v[4:7]
v_mfma_f32_16x16x32_bf16 v[8:11], a[80:83], v[76:79], v[8:11]
v_mfma_f32_16x16x32_bf16 v[4:7], a[20:23], v[80:83], v[4:7]
v_mfma_f32_16x16x32_bf16 v[8:11], a[84:87], v[80:83], v[8:11]
v_mfma_f32_16x16x32_bf16 v[4:7], a[24:27], v[84:87], v[4:7]
v_mfma_f32_16x16x32_bf16 v[8:11], a[88:91], v[84:87], v[8:11]
v_mfma_f32_16x16x32_bf16 v[4:7], a[28:31], v[88:91], v[4:7]
v_mfma_f32_16x16x32_bf16 v[8:11], a[92:95], v[88:91], v[8:11]
s_lshl_b32 s60, s15, 1
s_add_u32 s60, s60, 8
s_and_b32 s60, s60, 15
s_lshl_b32 s60, s60, 6
buffer_load_dwordx4 v[60:63], v122, s[56:59], s60 offen
s_lshl_b32 s60, s15, 1
s_add_u32 s60, s60, 9
s_and_b32 s60, s60, 15
s_lshl_b32 s60, s60, 6
buffer_load_dwordx4 v[64:67], v122, s[56:59], s60 offen
s_lshl_b32 s60, s15, 1
s_add_u32 s60, s60, 10
s_and_b32 s60, s60, 15
s_lshl_b32 s60, s60, 6
buffer_load_dwordx4 v[68:71], v122, s[56:59], s60 offen
s_lshl_b32 s60, s15, 1
s_add_u32 s60, s60, 11
s_and_b32 s60, s60, 15
s_lshl_b32 s60, s60, 6
buffer_load_dwordx4 v[72:75], v122, s[56:59], s60 offen
s_lshl_b32 s60, s15, 1
s_add_u32 s60, s60, 12
s_and_b32 s60, s60, 15
s_lshl_b32 s60, s60, 6
buffer_load_dwordx4 v[76:79], v122, s[56:59], s60 offen
s_lshl_b32 s60, s15, 1
s_add_u32 s60, s60, 13
s_and_b32 s60, s60, 15
s_lshl_b32 s60, s60, 6
buffer_load_dwordx4 v[80:83], v122, s[56:59], s60 offen
s_lshl_b32 s60, s15, 1
s_add_u32 s60, s60, 14
s_and_b32 s60, s60, 15
s_lshl_b32 s60, s60, 6
buffer_load_dwordx4 v[84:87], v122, s[56:59], s60 offen
s_lshl_b32 s60, s15, 1
s_add_u32 s60, s60, 15
s_and_b32 s60, s60, 15
s_lshl_b32 s60, s60, 6
buffer_load_dwordx4 v[88:91], v122, s[56:59], s60 offen
s_waitcnt vmcnt(0)
v_mfma_f32_16x16x32_bf16 v[4:7], a[32:35], v[60:63], v[4:7]
v_mfma_f32_16x16x32_bf16 v[8:11], a[96:99], v[60:63], v[8:11]
v_mfma_f32_16x16x32_bf16 v[4:7], a[36:39], v[64:67], v[4:7]
v_mfma_f32_16x16x32_bf16 v[8:11], a[100:103], v[64:67], v[8:11]
v_mfma_f32_16x16x32_bf16 v[4:7], a[40:43], v[68:71], v[4:7]
v_mfma_f32_16x16x32_bf16 v[8:11], a[104:107], v[68:71], v[8:11]
v_mfma_f32_16x16x32_bf16 v[4:7], a[44:47], v[72:75], v[4:7]
v_mfma_f32_16x16x32_bf16 v[8:11], a[108:111], v[72:75], v[8:11]
v_mfma_f32_16x16x32_bf16 v[4:7], a[48:51], v[76:79], v[4:7]
v_mfma_f32_16x16x32_bf16 v[8:11], a[112:115], v[76:79], v[8:11]
v_mfma_f32_16x16x32_bf16 v[4:7], a[52:55], v[80:83], v[4:7]
v_mfma_f32_16x16x32_bf16 v[8:11], a[116:119], v[80:83], v[8:11]
v_mfma_f32_16x16x32_bf16 v[4:7], a[56:59], v[84:87], v[4:7]
v_mfma_f32_16x16x32_bf16 v[8:11], a[120:123], v[84:87], v[8:11]
v_mfma_f32_16x16x32_bf16 v[4:7], a[60:63], v[88:91], v[4:7]
v_mfma_f32_16x16x32_bf16 v[8:11], a[124:127], v[88:91], v[8:11]
s_nop 6
v_mul_f32 v4, 0xbfb8aa3b, v4
v_mul_f32 v5, 0xbfb8aa3b, v5
v_mul_f32 v6, 0xbfb8aa3b, v6
v_mul_f32 v7, 0xbfb8aa3b, v7
v_mul_f32 v8, 0xbfb8aa3b, v8
v_mul_f32 v9, 0xbfb8aa3b, v9
v_mul_f32 v10, 0xbfb8aa3b, v10
v_mul_f32 v11, 0xbfb8aa3b, v11
v_exp_f32 v4, v4
v_exp_f32 v5, v5
v_exp_f32 v6, v6
v_exp_f32 v7, v7
v_exp_f32 v8, v8
v_exp_f32 v9, v9
v_exp_f32 v10, v10
v_exp_f32 v11, v11
v_add_f32 v4, 1.0, v4
v_add_f32 v5, 1.0, v5
v_add_f32 v6, 1.0, v6
v_add_f32 v7, 1.0, v7
v_add_f32 v8, 1.0, v8
v_add_f32 v9, 1.0, v9
v_add_f32 v10, 1.0, v10
v_add_f32 v11, 1.0, v11
v_rcp_f32 v4, v4
v_rcp_f32 v5, v5
v_rcp_f32 v6, v6
v_rcp_f32 v7, v7
v_rcp_f32 v8, v8
v_rcp_f32 v9, v9
v_rcp_f32 v10, v10
v_rcp_f32 v11, v11
s_lshl_b32 s60, s9, 9
s_lshl_b32 s61, s7, 7
s_add_u32 s60, s60, s61
s_add_u32 s60, s60, 15335424
s_mov_b64 s[68:69], exec
s_mov_b32 exec_lo, 0x00010001
s_mov_b32 exec_hi, 0x00010001
buffer_store_dwordx4 v[4:7], v122, s[48:51], s60 offen offset:0 sc1
buffer_store_dwordx4 v[8:11], v122, s[48:51], s60 offen offset:64 sc1
s_mov_b64 exec, s[68:69]
gate_44:
v_lshlrev_b32 v116, 4, v0
s_lshl_b32 s60, s7, 10
s_add_u32 s60, s60, 131072
v_add_u32 v117, s60, v116
s_cmp_lg_u32 s8, 0
s_cbranch_scc1 if_45
s_cmp_lg_u32 s73, 0
s_cbranch_scc1 sfo_47
s_mov_b32 s65, 0
sf_46:
s_waitcnt vmcnt(0)
v_xor_b32 v2, s4, v93
v_xor_b32 v95, s4, v95
v_or_b32 v2, v2, v95
v_xor_b32 v97, s4, v97
v_or_b32 v2, v2, v97
v_xor_b32 v99, s4, v99
v_or_b32 v2, v2, v99
v_xor_b32 v101, s4, v101
v_or_b32 v2, v2, v101
v_xor_b32 v103, s4, v103
v_or_b32 v2, v2, v103
v_xor_b32 v119, s4, v119
v_or_b32 v2, v2, v119
v_xor_b32 v121, s4, v121
v_or_b32 v2, v2, v121
v_cmp_ne_u32 vcc, 0, v2
s_nop 4
s_cbranch_vccz sfo_47
s_add_u32 s65, s65, 1
s_cmp_ge_u32 s65, 100000
s_cbranch_scc1 sfo_47
s_sleep 1
v_lshlrev_b32 v3, 3, v0
s_lshl_b32 s67, s9, 2
s_add_u32 s67, s67, s7
s_lshl_b32 s67, s67, 12
s_add_u32 s67, s67, 15400960
buffer_load_dwordx2 v[92:93], v3, s[48:51], s67 offen offset:0 sc1
buffer_load_dwordx2 v[94:95], v3, s[48:51], s67 offen offset:512 sc1
buffer_load_dwordx2 v[96:97], v3, s[48:51], s67 offen offset:1024 sc1
buffer_load_dwordx2 v[98:99], v3, s[48:51], s67 offen offset:1536 sc1
buffer_load_dwordx2 v[100:101], v3, s[48:51], s67 offen offset:2048 sc1
buffer_load_dwordx2 v[102:103], v3, s[48:51], s67 offen offset:2560 sc1
buffer_load_dwordx2 v[118:119], v3, s[48:51], s67 offen offset:3072 sc1
buffer_load_dwordx2 v[120:121], v3, s[48:51], s67 offen offset:3584 sc1
s_branch sf_46
sfo_47:
v_add_f32 v92, v92, v94
v_add_f32 v96, v96, v98
v_add_f32 v100, v100, v102
v_add_f32 v118, v118, v120
v_add_f32 v92, v92, v96
v_add_f32 v100, v100, v118
v_add_f32 v92, v92, v100
v_mul_f32 v60, 0x3abe82fa, v92
v_mov_b32 v61, v60
s_nop 1
v_permlane16_swap_b32 v60, v61
v_fma_f32 v61, -v60, v60, v61
v_max_f32 v61, 0, v61
v_add_f32 v61, 0x3727c5ac, v61
v_rsq_f32 v61, v61
s_nop 0
v_mul_f32 v60, v60, v61
v_mov_b32 v62, v60
v_mov_b32 v63, v61
s_nop 0
v_permlane32_swap_b32 v60, v62
v_permlane32_swap_b32 v61, v63
ds_write_b128 v117, v[60:63]
s_waitcnt lgkmcnt(0)
if_45:
v_and_b32 v119, 15, v0
v_lshrrev_b32 v120, 4, v0
v_lshlrev_b32 v120, 2, v120
v_sub_u32 v119, v119, v120
v_mov_b32 v120, 0x3f80
v_mov_b32 v121, 0x3f800000
v_cmp_eq_u32 vcc, 0, v119
s_nop 1
v_cndmask_b32 v124, 0, v120, vcc
v_cmp_eq_u32 vcc, 1, v119
s_nop 1
v_cndmask_b32 v124, v124, v121, vcc
v_cmp_eq_u32 vcc, 2, v119
s_nop 1
v_cndmask_b32 v125, 0, v120, vcc
v_cmp_eq_u32 vcc, 3, v119
s_nop 1
v_cndmask_b32 v125, v125, v121, vcc
v_lshrrev_b32 v84, 4, v0
v_and_b32 v85, 15, v0
v_lshrrev_b32 v86, 1, v84
v_xor_b32 v86, v86, v85
v_lshlrev_b32 v86, 4, v86
v_and_b32 v87, 1, v84
v_lshl_add_u32 v86, v87, 3, v86
v_lshl_add_u32 v86, v85, 8, v86
s_lshl_b32 s60, s8, 13
v_add_u32 v102, s60, v86
v_xor_b32 v103, 32, v102
v_xor_b32 v104, 64, v102
v_xor_b32 v105, 96, v102
v_xor_b32 v106, 128, v102
v_xor_b32 v107, 160, v102
v_xor_b32 v108, 192, v102
v_xor_b32 v109, 224, v102
s_barrier
s_cmp_eq_u32 s8, 0
s_cbranch_scc1 if_48
ds_read_b128 v[60:63], v117
s_waitcnt lgkmcnt(0)
if_48:
v_mov_b32 v64, v61
v_mov_b32 v68, v60
v_mov_b32 v65, v61
v_mov_b32 v69, v60
v_mov_b32 v66, v63
v_mov_b32 v70, v62
v_mov_b32 v67, v63
v_mov_b32 v71, v62
v_pk_fma_f32 v[4:5], v[4:5], v[64:65], v[68:69] neg_lo:[0,0,1] neg_hi:[0,0,1]
v_pk_fma_f32 v[6:7], v[6:7], v[64:65], v[68:69] neg_lo:[0,0,1] neg_hi:[0,0,1]
v_pk_fma_f32 v[8:9], v[8:9], v[66:67], v[70:71] neg_lo:[0,0,1] neg_hi:[0,0,1]
v_pk_fma_f32 v[10:11], v[10:11], v[66:67], v[70:71] neg_lo:[0,0,1] neg_hi:[0,0,1]
v_cvt_pk_bf16_f32 v72, v4, v5
v_cvt_pk_bf16_f32 v73, v6, v7
v_cvt_pk_bf16_f32 v74, v8, v9
v_cvt_pk_bf16_f32 v75, v10, v11
v_mfma_f32_16x16x16_bf16 v[4:7], v[72:73], v[124:125], 0
s_nop 0
v_mfma_f32_16x16x16_bf16 v[8:11], v[74:75], v[124:125], 0
v_pk_fma_f32 v[12:13], v[12:13], v[64:65], v[68:69] neg_lo:[0,0,1] neg_hi:[0,0,1]
v_pk_fma_f32 v[14:15], v[14:15], v[64:65], v[68:69] neg_lo:[0,0,1] neg_hi:[0,0,1]
v_pk_fma_f32 v[16:17], v[16:17], v[66:67], v[70:71] neg_lo:[0,0,1] neg_hi:[0,0,1]
v_pk_fma_f32 v[18:19], v[18:19], v[66:67], v[70:71] neg_lo:[0,0,1] neg_hi:[0,0,1]
v_cvt_pk_bf16_f32 v88, v12, v13
v_cvt_pk_bf16_f32 v89, v14, v15
v_cvt_pk_bf16_f32 v90, v16, v17
v_cvt_pk_bf16_f32 v91, v18, v19
v_mfma_f32_16x16x16_bf16 v[12:15], v[88:89], v[124:125], 0
s_nop 0
v_mfma_f32_16x16x16_bf16 v[16:19], v[90:91], v[124:125], 0
v_pk_fma_f32 v[20:21], v[20:21], v[64:65], v[68:69] neg_lo:[0,0,1] neg_hi:[0,0,1]
v_pk_fma_f32 v[22:23], v[22:23], v[64:65], v[68:69] neg_lo:[0,0,1] neg_hi:[0,0,1]
v_pk_fma_f32 v[24:25], v[24:25], v[66:67], v[70:71] neg_lo:[0,0,1] neg_hi:[0,0,1]
v_pk_fma_f32 v[26:27], v[26:27], v[66:67], v[70:71] neg_lo:[0,0,1] neg_hi:[0,0,1]
v_cvt_pk_bf16_f32 v72, v20, v21
v_cvt_pk_bf16_f32 v73, v22, v23
v_cvt_pk_bf16_f32 v74, v24, v25
v_cvt_pk_bf16_f32 v75, v26, v27
v_mfma_f32_16x16x16_bf16 v[20:23], v[72:73], v[124:125], 0
s_nop 0
v_mfma_f32_16x16x16_bf16 v[24:27], v[74:75], v[124:125], 0
v_cvt_pk_bf16_f32 v76, v4, v5
v_cvt_pk_bf16_f32 v77, v6, v7
v_cvt_pk_bf16_f32 v78, v8, v9
v_cvt_pk_bf16_f32 v79, v10, v11
v_cvt_pk_bf16_f32 v80, v12, v13
v_cvt_pk_bf16_f32 v81, v14, v15
v_cvt_pk_bf16_f32 v82, v16, v17
v_cvt_pk_bf16_f32 v83, v18, v19
v_cvt_pk_bf16_f32 v84, v20, v21
v_cvt_pk_bf16_f32 v85, v22, v23
v_cvt_pk_bf16_f32 v86, v24, v25
v_cvt_pk_bf16_f32 v87, v26, v27
s_mul_i32 s60, s7, 3072
s_add_u32 s60, s60, 135168
v_add_u32 v117, s60, v116
s_cmp_eq_u32 s8, 0
s_cbranch_scc1 if_49
ds_write_b128 v117, v[76:79] offset:0
ds_write_b128 v117, v[80:83] offset:1024
ds_write_b128 v117, v[84:87] offset:2048
s_waitcnt lgkmcnt(0)
if_49:
s_barrier
s_lshl_b32 s72, s71, 6
s_lshl_b32 s61, s9, 2
s_add_u32 s72, s72, s61
s_add_u32 s72, s72, s7
s_lshl_b32 s72, s72, 10
s_cmp_lg_u32 s8, 0
s_cbranch_scc1 if_50
ds_read_b128 v[4:7], v117 offset:0
ds_read_b128 v[8:11], v117 offset:1024
ds_read_b128 v[12:15], v117 offset:2048
s_add_u32 s61, s72, 0
s_cmp_gt_u32 s13, 0
s_cselect_b32 s61, s61, 15794176
buffer_store_dwordx4 v[76:79], v116, s[48:51], s61 offen offset:0 sc1
s_add_u32 s61, s72, 65536
s_cmp_gt_u32 s13, 1
s_cselect_b32 s61, s61, 15794176
buffer_store_dwordx4 v[80:83], v116, s[48:51], s61 offen offset:0 sc1
s_add_u32 s61, s72, 131072
s_cmp_gt_u32 s13, 2
s_cselect_b32 s61, s61, 15794176
buffer_store_dwordx4 v[84:87], v116, s[48:51], s61 offen offset:0 sc1
s_waitcnt lgkmcnt(0)
s_add_u32 s61, s72, 196608
s_cmp_lg_u32 s14, 7
s_cselect_b32 s61, s61, 15794176
buffer_store_dwordx4 v[4:7], v116, s[48:51], s61 offen offset:0 sc1
s_add_u32 s61, s72, 262144
s_cmp_lg_u32 s14, 7
s_cselect_b32 s61, s61, 15794176
buffer_store_dwordx4 v[8:11], v116, s[48:51], s61 offen offset:0 sc1
s_add_u32 s61, s72, 327680
s_cmp_lg_u32 s14, 7
s_cselect_b32 s61, s61, 15794176
buffer_store_dwordx4 v[12:15], v116, s[48:51], s61 offen offset:0 sc1
if_50:
s_cmp_eq_u32 s8, 0
s_cbranch_scc1 if_51
s_lshl_b32 m0, s7, 12
s_add_u32 m0, m0, 98304
s_add_u32 s66, s5, 1
s_and_b32 s66, s66, 3
s_lshl_b32 s66, s66, 8
s_add_u32 s66, s66, 2048
buffer_load_dwordx4 v98, s[52:55], s66 offen offset:0  lds
buffer_load_dwordx4 v99, s[52:55], s66 offen offset:1024  lds
buffer_load_dwordx4 v100, s[52:55], s66 offen offset:2048  lds
buffer_load_dwordx4 v101, s[52:55], s66 offen offset:3072  lds
s_lshl_b32 m0, s7, 12
s_add_u32 m0, m0, 114688
s_add_u32 s66, s5, 1
s_and_b32 s66, s66, 3
s_lshl_b32 s66, s66, 8
s_add_u32 s66, s66, 3072
buffer_load_dwordx4 v98, s[52:55], s66 offen offset:0  lds
buffer_load_dwordx4 v99, s[52:55], s66 offen offset:1024  lds
buffer_load_dwordx4 v100, s[52:55], s66 offen offset:2048  lds
buffer_load_dwordx4 v101, s[52:55], s66 offen offset:3072  lds
if_51:
s_cmp_eq_u32 s8, 0
s_cbranch_scc1 if_52
s_waitcnt vmcnt(16)
if_52:
s_barrier
s_lshl_b32 s60, s7, 14
s_add_u32 s60, s60, 0
v_add_u32 v60, s60, v102
v_add_u32 v61, s60, v103
v_add_u32 v62, s60, v104
v_add_u32 v63, s60, v105
v_add_u32 v64, s60, v106
v_add_u32 v65, s60, v107
v_add_u32 v66, s60, v108
v_add_u32 v67, s60, v109
ds_read_b64 a[0:1], v60 offset:0
ds_read_b64 a[2:3], v61 offset:0
ds_read_b64 a[64:65], v60 offset:4096
ds_read_b64 a[66:67], v61 offset:4096
ds_read_b64 a[4:5], v62 offset:0
ds_read_b64 a[6:7], v63 offset:0
ds_read_b64 a[68:69], v62 offset:4096
ds_read_b64 a[70:71], v63 offset:4096
ds_read_b64 a[8:9], v64 offset:0
ds_read_b64 a[10:11], v65 offset:0
ds_read_b64 a[72:73], v64 offset:4096
ds_read_b64 a[74:75], v65 offset:4096
s_waitcnt lgkmcnt(6)
ds_read_b64 a[12:13], v66 offset:0
ds_read_b64 a[14:15], v67 offset:0
ds_read_b64 a[76:77], v66 offset:4096
ds_read_b64 a[78:79], v67 offset:4096
s_waitcnt lgkmcnt(0)
s_barrier
s_cmp_lg_u32 s8, 0
s_cbranch_scc1 if_53
s_waitcnt vmcnt(0)
s_mov_b64 s[68:69], exec
s_mov_b64 exec, 1
v_mov_b32 v2, 159744
v_mov_b32 v3, 1
ds_add_rtn_u32 v2, v2, v3
s_waitcnt lgkmcnt(0)
v_readfirstlane_b32 s64, v2
s_mov_b64 exec, s[68:69]
s_nop 2
s_cmp_lg_u32 s64, 3
s_cbranch_scc1 if_54
s_lshl_b32 s60, s14, 8
s_add_u32 s60, s60, 15732736
s_mov_b64 s[68:69], exec
s_mov_b64 exec, 1
v_mov_b32 v2, 1
v_mov_b32 v3, 0
buffer_atomic_add v2, v3, s[48:51], s60 offen sc1
s_mov_b64 exec, s[68:69]
if_54:
s_lshl_b32 s60, s9, 2
s_add_u32 s60, s60, s7
s_mul_i32 s60, s60, 43
s_add_u32 s60, s60, s70
s_lshl_b32 s60, s60, 10
s_add_u32 s60, s60, 3145728
s_cmp_eq_u32 s14, 7
s_cselect_b32 s62, 1, 4
v_cvt_pk_bf16_f32 v16, v28, v29
v_cvt_pk_bf16_f32 v17, v30, v31
v_cvt_pk_bf16_f32 v18, v32, v33
v_cvt_pk_bf16_f32 v19, v34, v35
v_cvt_pk_bf16_f32 v20, v36, v37
v_cvt_pk_bf16_f32 v21, v38, v39
v_cvt_pk_bf16_f32 v22, v40, v41
v_cvt_pk_bf16_f32 v23, v42, v43
v_cvt_pk_bf16_f32 v24, v44, v45
v_cvt_pk_bf16_f32 v25, v46, v47
v_cvt_pk_bf16_f32 v26, v48, v49
v_cvt_pk_bf16_f32 v27, v50, v51
v_cvt_pk_bf16_f32 v28, v52, v53
v_cvt_pk_bf16_f32 v29, v54, v55
v_cvt_pk_bf16_f32 v30, v56, v57
v_cvt_pk_bf16_f32 v31, v58, v59
s_add_u32 s61, s60, 0
s_cmp_gt_u32 s62, 0
s_cselect_b32 s61, s61, 15794176
buffer_store_dwordx4 v[16:19], v116, s[48:51], s61 offen offset:0 sc1
s_add_u32 s61, s60, 1024
s_cmp_gt_u32 s62, 1
s_cselect_b32 s61, s61, 15794176
buffer_store_dwordx4 v[20:23], v116, s[48:51], s61 offen offset:0 sc1
s_add_u32 s61, s60, 2048
s_cmp_gt_u32 s62, 2
s_cselect_b32 s61, s61, 15794176
buffer_store_dwordx4 v[24:27], v116, s[48:51], s61 offen offset:0 sc1
s_add_u32 s61, s60, 3072
s_cmp_gt_u32 s62, 3
s_cselect_b32 s61, s61, 15794176
buffer_store_dwordx4 v[28:31], v116, s[48:51], s61 offen offset:0 sc1
if_53:
s_cmp_eq_u32 s8, 0
s_cbranch_scc1 if_55
s_lshl_b32 m0, s7, 12
s_add_u32 m0, m0, 0
s_add_u32 s66, s5, 2
s_and_b32 s66, s66, 3
s_lshl_b32 s66, s66, 8
buffer_load_dwordx4 v98, s[52:55], s66 offen offset:0  lds
buffer_load_dwordx4 v99, s[52:55], s66 offen offset:1024  lds
buffer_load_dwordx4 v100, s[52:55], s66 offen offset:2048  lds
buffer_load_dwordx4 v101, s[52:55], s66 offen offset:3072  lds
s_lshl_b32 m0, s7, 12
s_add_u32 m0, m0, 16384
s_add_u32 s66, s5, 2
s_and_b32 s66, s66, 3
s_lshl_b32 s66, s66, 8
s_add_u32 s66, s66, 1024
buffer_load_dwordx4 v98, s[52:55], s66 offen offset:0  lds
buffer_load_dwordx4 v99, s[52:55], s66 offen offset:1024  lds
buffer_load_dwordx4 v100, s[52:55], s66 offen offset:2048  lds
buffer_load_dwordx4 v101, s[52:55], s66 offen offset:3072  lds
s_lshl_b32 m0, s7, 12
s_add_u32 m0, m0, 32768
s_add_u32 s66, s5, 2
s_and_b32 s66, s66, 3
s_lshl_b32 s66, s66, 8
s_add_u32 s66, s66, 2048
buffer_load_dwordx4 v98, s[52:55], s66 offen offset:0  lds
buffer_load_dwordx4 v99, s[52:55], s66 offen offset:1024  lds
buffer_load_dwordx4 v100, s[52:55], s66 offen offset:2048  lds
buffer_load_dwordx4 v101, s[52:55], s66 offen offset:3072  lds
s_lshl_b32 m0, s7, 12
s_add_u32 m0, m0, 49152
s_add_u32 s66, s5, 2
s_and_b32 s66, s66, 3
s_lshl_b32 s66, s66, 8
s_add_u32 s66, s66, 3072
buffer_load_dwordx4 v98, s[52:55], s66 offen offset:0  lds
buffer_load_dwordx4 v99, s[52:55], s66 offen offset:1024  lds
buffer_load_dwordx4 v100, s[52:55], s66 offen offset:2048  lds
buffer_load_dwordx4 v101, s[52:55], s66 offen offset:3072  lds
if_55:
s_cmp_eq_u32 s8, 0
s_cbranch_scc1 if_56
s_lshl_b32 s60, s9, 2
s_add_u32 s60, s60, s7
s_mul_i32 s60, s60, 43
s_add_u32 s60, s60, s70
s_add_u32 s60, s60, 4
s_lshl_b32 s60, s60, 10
s_add_u32 s60, s60, 3145728
s_cmp_eq_u32 s14, 7
s_cselect_b32 s62, 0, 2
v_cvt_pk_bf16_f32 v16, v28, v29
v_cvt_pk_bf16_f32 v17, v30, v31
v_cvt_pk_bf16_f32 v18, v32, v33
v_cvt_pk_bf16_f32 v19, v34, v35
v_cvt_pk_bf16_f32 v20, v36, v37
v_cvt_pk_bf16_f32 v21, v38, v39
v_cvt_pk_bf16_f32 v22, v40, v41
v_cvt_pk_bf16_f32 v23, v42, v43
s_add_u32 s61, s60, 0
s_cmp_gt_u32 s62, 0
s_cselect_b32 s61, s61, 15794176
buffer_store_dwordx4 v[16:19], v116, s[48:51], s61 offen offset:0 sc1
s_add_u32 s61, s60, 1024
s_cmp_gt_u32 s62, 1
s_cselect_b32 s61, s61, 15794176
buffer_store_dwordx4 v[20:23], v116, s[48:51], s61 offen offset:0 sc1
s_waitcnt vmcnt(18)
if_56:
s_barrier
s_lshl_b32 s60, s7, 14
s_add_u32 s60, s60, 65536
v_add_u32 v60, s60, v102
v_add_u32 v61, s60, v103
v_add_u32 v62, s60, v104
v_add_u32 v63, s60, v105
v_add_u32 v64, s60, v106
v_add_u32 v65, s60, v107
v_add_u32 v66, s60, v108
v_add_u32 v67, s60, v109
ds_read_b64 a[16:17], v60 offset:0
ds_read_b64 a[18:19], v61 offset:0
ds_read_b64 a[80:81], v60 offset:4096
ds_read_b64 a[82:83], v61 offset:4096
ds_read_b64 a[20:21], v62 offset:0
ds_read_b64 a[22:23], v63 offset:0
ds_read_b64 a[84:85], v62 offset:4096
ds_read_b64 a[86:87], v63 offset:4096
ds_read_b64 a[24:25], v64 offset:0
ds_read_b64 a[26:27], v65 offset:0
ds_read_b64 a[88:89], v64 offset:4096
ds_read_b64 a[90:91], v65 offset:4096
s_waitcnt lgkmcnt(6)
ds_read_b64 a[28:29], v66 offset:0
ds_read_b64 a[30:31], v67 offset:0
ds_read_b64 a[92:93], v66 offset:4096
ds_read_b64 a[94:95], v67 offset:4096
s_waitcnt lgkmcnt(0)
s_barrier
s_cmp_eq_u32 s8, 0
s_cbranch_scc1 if_57
s_lshl_b32 m0, s7, 12
s_add_u32 m0, m0, 65536
s_add_u32 s66, s5, 3
s_and_b32 s66, s66, 3
s_lshl_b32 s66, s66, 8
buffer_load_dwordx4 v98, s[52:55], s66 offen offset:0  lds
buffer_load_dwordx4 v99, s[52:55], s66 offen offset:1024  lds
buffer_load_dwordx4 v100, s[52:55], s66 offen offset:2048  lds
buffer_load_dwordx4 v101, s[52:55], s66 offen offset:3072  lds
s_lshl_b32 m0, s7, 12
s_add_u32 m0, m0, 81920
s_add_u32 s66, s5, 3
s_and_b32 s66, s66, 3
s_lshl_b32 s66, s66, 8
s_add_u32 s66, s66, 1024
buffer_load_dwordx4 v98, s[52:55], s66 offen offset:0  lds
buffer_load_dwordx4 v99, s[52:55], s66 offen offset:1024  lds
buffer_load_dwordx4 v100, s[52:55], s66 offen offset:2048  lds
buffer_load_dwordx4 v101, s[52:55], s66 offen offset:3072  lds
s_lshl_b32 m0, s7, 12
s_add_u32 m0, m0, 98304
s_add_u32 s66, s5, 3
s_and_b32 s66, s66, 3
s_lshl_b32 s66, s66, 8
s_add_u32 s66, s66, 2048
buffer_load_dwordx4 v98, s[52:55], s66 offen offset:0  lds
buffer_load_dwordx4 v99, s[52:55], s66 offen offset:1024  lds
buffer_load_dwordx4 v100, s[52:55], s66 offen offset:2048  lds
buffer_load_dwordx4 v101, s[52:55], s66 offen offset:3072  lds
s_lshl_b32 m0, s7, 12
s_add_u32 m0, m0, 114688
s_add_u32 s66, s5, 3
s_and_b32 s66, s66, 3
s_lshl_b32 s66, s66, 8
s_add_u32 s66, s66, 3072
buffer_load_dwordx4 v98, s[52:55], s66 offen offset:0  lds
buffer_load_dwordx4 v99, s[52:55], s66 offen offset:1024  lds
buffer_load_dwordx4 v100, s[52:55], s66 offen offset:2048  lds
buffer_load_dwordx4 v101, s[52:55], s66 offen offset:3072  lds
if_57:
s_cmp_eq_u32 s8, 0
s_cbranch_scc1 if_58
s_waitcnt vmcnt(16)
if_58:
s_barrier
s_lshl_b32 s60, s7, 14
s_add_u32 s60, s60, 0
v_add_u32 v60, s60, v102
v_add_u32 v61, s60, v103
v_add_u32 v62, s60, v104
v_add_u32 v63, s60, v105
v_add_u32 v64, s60, v106
v_add_u32 v65, s60, v107
v_add_u32 v66, s60, v108
v_add_u32 v67, s60, v109
ds_read_b64 a[32:33], v60 offset:0
ds_read_b64 a[34:35], v61 offset:0
ds_read_b64 a[96:97], v60 offset:4096
ds_read_b64 a[98:99], v61 offset:4096
ds_read_b64 a[36:37], v62 offset:0
ds_read_b64 a[38:39], v63 offset:0
ds_read_b64 a[100:101], v62 offset:4096
ds_read_b64 a[102:103], v63 offset:4096
ds_read_b64 a[40:41], v64 offset:0
ds_read_b64 a[42:43], v65 offset:0
ds_read_b64 a[104:105], v64 offset:4096
ds_read_b64 a[106:107], v65 offset:4096
s_waitcnt lgkmcnt(6)
ds_read_b64 a[44:45], v66 offset:0
ds_read_b64 a[46:47], v67 offset:0
ds_read_b64 a[108:109], v66 offset:4096
ds_read_b64 a[110:111], v67 offset:4096
s_waitcnt vmcnt(0)
s_barrier
s_cmp_lg_u32 s6, 0
s_cbranch_scc1 if_59
s_lshl_b32 s60, s14, 8
s_add_u32 s60, s60, 15747072
s_mov_b64 s[68:69], exec
s_mov_b64 exec, 1
v_mov_b32 v2, 1
v_mov_b32 v3, 0
buffer_atomic_add v2, v3, s[48:51], s60 offen sc1
s_mov_b64 exec, s[68:69]
if_59:
s_lshl_b32 s60, s7, 14
s_add_u32 s60, s60, 65536
v_add_u32 v60, s60, v102
v_add_u32 v61, s60, v103
v_add_u32 v62, s60, v104
v_add_u32 v63, s60, v105
v_add_u32 v64, s60, v106
v_add_u32 v65, s60, v107
v_add_u32 v66, s60, v108
v_add_u32 v67, s60, v109
ds_read_b64 a[48:49], v60 offset:0
ds_read_b64 a[50:51], v61 offset:0
ds_read_b64 a[112:113], v60 offset:4096
ds_read_b64 a[114:115], v61 offset:4096
ds_read_b64 a[52:53], v62 offset:0
ds_read_b64 a[54:55], v63 offset:0
ds_read_b64 a[116:117], v62 offset:4096
ds_read_b64 a[118:119], v63 offset:4096
ds_read_b64 a[56:57], v64 offset:0
ds_read_b64 a[58:59], v65 offset:0
ds_read_b64 a[120:121], v64 offset:4096
ds_read_b64 a[122:123], v65 offset:4096
s_waitcnt lgkmcnt(6)
ds_read_b64 a[60:61], v66 offset:0
ds_read_b64 a[62:63], v67 offset:0
ds_read_b64 a[124:125], v66 offset:4096
ds_read_b64 a[126:127], v67 offset:4096
s_waitcnt lgkmcnt(0)
p1end_4:
s_and_b32 s60, s2, 7
s_lshr_b32 s61, s2, 3
s_mov_b32 s9, s96
s_and_b32 s62, s60, 1
s_lshl_b32 s62, s62, 2
s_lshr_b32 s63, s61, 3
s_add_u32 s10, s62, s63
s_mul_i32 s11, s10, 6
s_add_u32 s11, s11, 1
s_cmp_eq_u32 s10, 7
s_cselect_b32 s11, 0, s11
s_cmp_lg_u32 s10, 7
s_cbranch_scc1 oj_60
s_lshr_b32 s12, s9, 1
s_cmp_lg_u32 s6, 0
s_cbranch_scc1 if_61
s_lshr_b32 s60, s9, 2
s_lshl_b32 s60, s60, 8
s_add_u32 s60, s60, 15734784
s_mov_b64 s[68:69], exec
v_mov_b32 v121, 0
v_mov_b32 v122, 0
v_writelane_b32 v121, s60, 0
s_movk_i32 s64, 16
v_writelane_b32 v122, s64, 0
s_mov_b64 exec, 1
s_mov_b32 s65, 0
pq_62:
buffer_load_dword v120, v121, s[48:51], 0 offen sc1
s_waitcnt vmcnt(0)
v_cmp_lt_u32 vcc, v120, v122
s_add_u32 s65, s65, 1
s_cmp_lt_u32 s65, 100000
s_cbranch_scc0 pqok_63
s_nop 1
s_cbranch_vccz pqok_63
s_sleep 1
s_branch pq_62
pqok_63:
s_mov_b64 exec, s[68:69]
if_61:
s_barrier
s_and_b32 s13, s9, 1
s_lshl_b32 s13, s13, 6
s_lshl_b32 s60, s6, 3
s_add_u32 s13, s13, s60
s_lshl_b32 s60, s12, 1
s_add_u32 s60, s60, s8
s_lshl_b32 s61, s7, 7
s_add_u32 s61, s61, s60
s_lshl_b32 s62, s61, 6
s_add_u32 s62, s62, 15204352
s_lshl_b32 s61, s61, 10
s_add_u32 s61, s61, 14680064
v_lshlrev_b32 v114, 4, v0
v_and_b32 v115, 0x30, v0
buffer_load_dwordx4 v[4:7], v114, s[48:51], s61 offen sc1
buffer_load_dwordx4 v[20:23], v115, s[48:51], s62 offen sc1
s_add_u32 s61, s61, 32768
s_add_u32 s62, s62, 2048
buffer_load_dwordx4 v[8:11], v114, s[48:51], s61 offen sc1
buffer_load_dwordx4 v[24:27], v115, s[48:51], s62 offen sc1
s_add_u32 s61, s61, 32768
s_add_u32 s62, s62, 2048
buffer_load_dwordx4 v[12:15], v114, s[48:51], s61 offen sc1
buffer_load_dwordx4 v[28:31], v115, s[48:51], s62 offen sc1
s_add_u32 s61, s61, 32768
s_add_u32 s62, s62, 2048
buffer_load_dwordx4 v[16:19], v114, s[48:51], s61 offen sc1
buffer_load_dwordx4 v[32:35], v115, s[48:51], s62 offen sc1
s_add_u32 s61, s61, 32768
s_add_u32 s62, s62, 2048
v_and_b32 v117, 15, v0
v_lshlrev_b32 v117, 2, v117
s_lshl_b32 s60, s12, 7
s_lshr_b32 s61, s13, 1
s_add_u32 s60, s60, s61
s_lshl_b32 s60, s60, 10
s_add_u32 s60, s60, 6291456
s_add_u32 s61, s60, 0
buffer_load_dwordx4 v[52:55], v114, s[48:51], s61 offen offset:0 sc1
buffer_load_dwordx4 v[56:59], v114, s[48:51], s61 offen offset:1024 sc1
buffer_load_dwordx4 v[60:63], v114, s[48:51], s61 offen offset:2048 sc1
buffer_load_dwordx4 v[64:67], v114, s[48:51], s61 offen offset:3072 sc1
s_add_u32 s61, s60, 65536
buffer_load_dwordx4 v[68:71], v114, s[48:51], s61 offen offset:0 sc1
buffer_load_dwordx4 v[72:75], v114, s[48:51], s61 offen offset:1024 sc1
buffer_load_dwordx4 v[76:79], v114, s[48:51], s61 offen offset:2048 sc1
buffer_load_dwordx4 v[80:83], v114, s[48:51], s61 offen offset:3072 sc1
s_waitcnt vmcnt(8)
v_pk_add_f32 v[4:5], v[4:5], v[8:9]
v_pk_add_f32 v[12:13], v[12:13], v[16:17]
v_pk_add_f32 v[6:7], v[6:7], v[10:11]
v_pk_add_f32 v[14:15], v[14:15], v[18:19]
v_pk_add_f32 v[4:5], v[4:5], v[12:13]
v_pk_add_f32 v[6:7], v[6:7], v[14:15]
v_pk_add_f32 v[20:21], v[20:21], v[24:25]
v_pk_add_f32 v[28:29], v[28:29], v[32:33]
v_pk_add_f32 v[22:23], v[22:23], v[26:27]
v_pk_add_f32 v[30:31], v[30:31], v[34:35]
v_pk_add_f32 v[20:21], v[20:21], v[28:29]
v_pk_add_f32 v[22:23], v[22:23], v[30:31]
s_lshl_b32 s60, s6, 11
s_add_u32 s60, s60, 0
v_add_u32 v118, s60, v114
ds_write_b128 v118, v[4:7]
ds_write_b128 v118, v[20:23] offset:1024
s_waitcnt lgkmcnt(0)
s_barrier
v_add_u32 v118, 0, v114
ds_read_b128 v[4:7], v118 offset:0
ds_read_b128 v[20:23], v118 offset:1024
ds_read_b128 v[8:11], v118 offset:2048
ds_read_b128 v[24:27], v118 offset:3072
ds_read_b128 v[12:15], v118 offset:4096
ds_read_b128 v[28:31], v118 offset:5120
ds_read_b128 v[16:19], v118 offset:6144
ds_read_b128 v[32:35], v118 offset:7168
s_waitcnt lgkmcnt(0)
v_pk_add_f32 v[4:5], v[4:5], v[8:9]
v_pk_add_f32 v[12:13], v[12:13], v[16:17]
v_pk_add_f32 v[6:7], v[6:7], v[10:11]
v_pk_add_f32 v[14:15], v[14:15], v[18:19]
v_pk_add_f32 v[4:5], v[4:5], v[12:13]
v_pk_add_f32 v[6:7], v[6:7], v[14:15]
v_cvt_pk_bf16_f32 v44, v4, v5
v_cvt_pk_bf16_f32 v45, v6, v7
v_pk_add_f32 v[20:21], v[20:21], v[24:25]
v_pk_add_f32 v[28:29], v[28:29], v[32:33]
v_pk_add_f32 v[22:23], v[22:23], v[26:27]
v_pk_add_f32 v[30:31], v[30:31], v[34:35]
v_pk_add_f32 v[20:21], v[20:21], v[28:29]
v_pk_add_f32 v[22:23], v[22:23], v[30:31]
v_cvt_pk_bf16_f32 v48, v20, v21
v_cvt_pk_bf16_f32 v49, v22, v23
ds_read_b128 v[4:7], v118 offset:8192
ds_read_b128 v[20:23], v118 offset:9216
ds_read_b128 v[8:11], v118 offset:10240
ds_read_b128 v[24:27], v118 offset:11264
ds_read_b128 v[12:15], v118 offset:12288
ds_read_b128 v[28:31], v118 offset:13312
ds_read_b128 v[16:19], v118 offset:14336
ds_read_b128 v[32:35], v118 offset:15360
s_waitcnt lgkmcnt(0)
v_pk_add_f32 v[4:5], v[4:5], v[8:9]
v_pk_add_f32 v[12:13], v[12:13], v[16:17]
v_pk_add_f32 v[6:7], v[6:7], v[10:11]
v_pk_add_f32 v[14:15], v[14:15], v[18:19]
v_pk_add_f32 v[4:5], v[4:5], v[12:13]
v_pk_add_f32 v[6:7], v[6:7], v[14:15]
v_cvt_pk_bf16_f32 v46, v4, v5
v_cvt_pk_bf16_f32 v47, v6, v7
v_pk_add_f32 v[20:21], v[20:21], v[24:25]
v_pk_add_f32 v[28:29], v[28:29], v[32:33]
v_pk_add_f32 v[22:23], v[22:23], v[26:27]
v_pk_add_f32 v[30:31], v[30:31], v[34:35]
v_pk_add_f32 v[20:21], v[20:21], v[28:29]
v_pk_add_f32 v[22:23], v[22:23], v[30:31]
v_cvt_pk_bf16_f32 v50, v20, v21
v_cvt_pk_bf16_f32 v51, v22, v23
s_waitcnt vmcnt(0)
s_mov_b32 s76, 0x358637bd
v_mfma_f32_16x16x16_bf16 v[4:7], v[44:45], v[52:53], 0
v_mfma_f32_16x16x16_bf16 v[12:15], v[48:49], v[52:53], 0
v_mfma_f32_16x16x16_bf16 v[8:11], v[46:47], v[68:69], 0
v_mfma_f32_16x16x16_bf16 v[16:19], v[50:51], v[68:69], 0
v_mfma_f32_16x16x16_bf16 v[20:23], v[44:45], v[54:55], 0
v_mfma_f32_16x16x16_bf16 v[28:31], v[48:49], v[54:55], 0
v_mfma_f32_16x16x16_bf16 v[24:27], v[46:47], v[70:71], 0
v_mfma_f32_16x16x16_bf16 v[32:35], v[50:51], v[70:71], 0
s_nop 1
v_add_f32 v12, s76, v12
s_nop 0
v_add_f32 v16, s76, v16
s_nop 0
v_add_f32 v28, s76, v28
s_nop 0
v_add_f32 v32, s76, v32
v_rcp_f32 v12, v12
v_rcp_f32 v16, v16
v_rcp_f32 v28, v28
v_rcp_f32 v32, v32
v_mov_b32 v13, v12
v_mov_b32 v17, v16
v_mov_b32 v29, v28
v_mov_b32 v33, v32
v_pk_mul_f32 v[4:5], v[4:5], v[12:13]
v_pk_mul_f32 v[6:7], v[6:7], v[12:13]
v_pk_mul_f32 v[8:9], v[8:9], v[16:17]
v_pk_mul_f32 v[10:11], v[10:11], v[16:17]
v_pk_mul_f32 v[20:21], v[20:21], v[28:29]
v_pk_mul_f32 v[22:23], v[22:23], v[28:29]
v_pk_mul_f32 v[24:25], v[24:25], v[32:33]
v_pk_mul_f32 v[26:27], v[26:27], v[32:33]
v_cvt_pk_bf16_f32 v36, v4, v5
v_cvt_pk_bf16_f32 v37, v6, v7
v_cvt_pk_bf16_f32 v38, v8, v9
v_cvt_pk_bf16_f32 v39, v10, v11
s_add_u32 s60, s13, 0
s_lshl_b32 s60, s60, 4
s_add_u32 s60, s60, s12
s_lshl_b32 s60, s60, 10
s_add_u32 s60, s60, 12058624
buffer_store_dwordx4 v[36:39], v114, s[48:51], s60 offen offset:0 sc1
v_cvt_pk_bf16_f32 v40, v20, v21
v_cvt_pk_bf16_f32 v41, v22, v23
v_cvt_pk_bf16_f32 v42, v24, v25
v_cvt_pk_bf16_f32 v43, v26, v27
s_add_u32 s60, s13, 1
s_lshl_b32 s60, s60, 4
s_add_u32 s60, s60, s12
s_lshl_b32 s60, s60, 10
s_add_u32 s60, s60, 12058624
buffer_store_dwordx4 v[40:43], v114, s[48:51], s60 offen offset:0 sc1
v_mfma_f32_16x16x16_bf16 v[4:7], v[44:45], v[56:57], 0
v_mfma_f32_16x16x16_bf16 v[12:15], v[48:49], v[56:57], 0
v_mfma_f32_16x16x16_bf16 v[8:11], v[46:47], v[72:73], 0
v_mfma_f32_16x16x16_bf16 v[16:19], v[50:51], v[72:73], 0
v_mfma_f32_16x16x16_bf16 v[20:23], v[44:45], v[58:59], 0
v_mfma_f32_16x16x16_bf16 v[28:31], v[48:49], v[58:59], 0
v_mfma_f32_16x16x16_bf16 v[24:27], v[46:47], v[74:75], 0
v_mfma_f32_16x16x16_bf16 v[32:35], v[50:51], v[74:75], 0
s_nop 1
v_add_f32 v12, s76, v12
s_nop 0
v_add_f32 v16, s76, v16
s_nop 0
v_add_f32 v28, s76, v28
s_nop 0
v_add_f32 v32, s76, v32
v_rcp_f32 v12, v12
v_rcp_f32 v16, v16
v_rcp_f32 v28, v28
v_rcp_f32 v32, v32
v_mov_b32 v13, v12
v_mov_b32 v17, v16
v_mov_b32 v29, v28
v_mov_b32 v33, v32
v_pk_mul_f32 v[4:5], v[4:5], v[12:13]
v_pk_mul_f32 v[6:7], v[6:7], v[12:13]
v_pk_mul_f32 v[8:9], v[8:9], v[16:17]
v_pk_mul_f32 v[10:11], v[10:11], v[16:17]
v_pk_mul_f32 v[20:21], v[20:21], v[28:29]
v_pk_mul_f32 v[22:23], v[22:23], v[28:29]
v_pk_mul_f32 v[24:25], v[24:25], v[32:33]
v_pk_mul_f32 v[26:27], v[26:27], v[32:33]
v_cvt_pk_bf16_f32 v36, v4, v5
v_cvt_pk_bf16_f32 v37, v6, v7
v_cvt_pk_bf16_f32 v38, v8, v9
v_cvt_pk_bf16_f32 v39, v10, v11
s_add_u32 s60, s13, 2
s_lshl_b32 s60, s60, 4
s_add_u32 s60, s60, s12
s_lshl_b32 s60, s60, 10
s_add_u32 s60, s60, 12058624
buffer_store_dwordx4 v[36:39], v114, s[48:51], s60 offen offset:0 sc1
v_cvt_pk_bf16_f32 v40, v20, v21
v_cvt_pk_bf16_f32 v41, v22, v23
v_cvt_pk_bf16_f32 v42, v24, v25
v_cvt_pk_bf16_f32 v43, v26, v27
s_add_u32 s60, s13, 3
s_lshl_b32 s60, s60, 4
s_add_u32 s60, s60, s12
s_lshl_b32 s60, s60, 10
s_add_u32 s60, s60, 12058624
buffer_store_dwordx4 v[40:43], v114, s[48:51], s60 offen offset:0 sc1
v_mfma_f32_16x16x16_bf16 v[4:7], v[44:45], v[60:61], 0
v_mfma_f32_16x16x16_bf16 v[12:15], v[48:49], v[60:61], 0
v_mfma_f32_16x16x16_bf16 v[8:11], v[46:47], v[76:77], 0
v_mfma_f32_16x16x16_bf16 v[16:19], v[50:51], v[76:77], 0
v_mfma_f32_16x16x16_bf16 v[20:23], v[44:45], v[62:63], 0
v_mfma_f32_16x16x16_bf16 v[28:31], v[48:49], v[62:63], 0
v_mfma_f32_16x16x16_bf16 v[24:27], v[46:47], v[78:79], 0
v_mfma_f32_16x16x16_bf16 v[32:35], v[50:51], v[78:79], 0
s_nop 1
v_add_f32 v12, s76, v12
s_nop 0
v_add_f32 v16, s76, v16
s_nop 0
v_add_f32 v28, s76, v28
s_nop 0
v_add_f32 v32, s76, v32
v_rcp_f32 v12, v12
v_rcp_f32 v16, v16
v_rcp_f32 v28, v28
v_rcp_f32 v32, v32
v_mov_b32 v13, v12
v_mov_b32 v17, v16
v_mov_b32 v29, v28
v_mov_b32 v33, v32
v_pk_mul_f32 v[4:5], v[4:5], v[12:13]
v_pk_mul_f32 v[6:7], v[6:7], v[12:13]
v_pk_mul_f32 v[8:9], v[8:9], v[16:17]
v_pk_mul_f32 v[10:11], v[10:11], v[16:17]
v_pk_mul_f32 v[20:21], v[20:21], v[28:29]
v_pk_mul_f32 v[22:23], v[22:23], v[28:29]
v_pk_mul_f32 v[24:25], v[24:25], v[32:33]
v_pk_mul_f32 v[26:27], v[26:27], v[32:33]
v_cvt_pk_bf16_f32 v36, v4, v5
v_cvt_pk_bf16_f32 v37, v6, v7
v_cvt_pk_bf16_f32 v38, v8, v9
v_cvt_pk_bf16_f32 v39, v10, v11
s_add_u32 s60, s13, 4
s_lshl_b32 s60, s60, 4
s_add_u32 s60, s60, s12
s_lshl_b32 s60, s60, 10
s_add_u32 s60, s60, 12058624
buffer_store_dwordx4 v[36:39], v114, s[48:51], s60 offen offset:0 sc1
v_cvt_pk_bf16_f32 v40, v20, v21
v_cvt_pk_bf16_f32 v41, v22, v23
v_cvt_pk_bf16_f32 v42, v24, v25
v_cvt_pk_bf16_f32 v43, v26, v27
s_add_u32 s60, s13, 5
s_lshl_b32 s60, s60, 4
s_add_u32 s60, s60, s12
s_lshl_b32 s60, s60, 10
s_add_u32 s60, s60, 12058624
buffer_store_dwordx4 v[40:43], v114, s[48:51], s60 offen offset:0 sc1
v_mfma_f32_16x16x16_bf16 v[4:7], v[44:45], v[64:65], 0
v_mfma_f32_16x16x16_bf16 v[12:15], v[48:49], v[64:65], 0
v_mfma_f32_16x16x16_bf16 v[8:11], v[46:47], v[80:81], 0
v_mfma_f32_16x16x16_bf16 v[16:19], v[50:51], v[80:81], 0
v_mfma_f32_16x16x16_bf16 v[20:23], v[44:45], v[66:67], 0
v_mfma_f32_16x16x16_bf16 v[28:31], v[48:49], v[66:67], 0
v_mfma_f32_16x16x16_bf16 v[24:27], v[46:47], v[82:83], 0
v_mfma_f32_16x16x16_bf16 v[32:35], v[50:51], v[82:83], 0
s_nop 1
v_add_f32 v12, s76, v12
s_nop 0
v_add_f32 v16, s76, v16
s_nop 0
v_add_f32 v28, s76, v28
s_nop 0
v_add_f32 v32, s76, v32
v_rcp_f32 v12, v12
v_rcp_f32 v16, v16
v_rcp_f32 v28, v28
v_rcp_f32 v32, v32
v_mov_b32 v13, v12
v_mov_b32 v17, v16
v_mov_b32 v29, v28
v_mov_b32 v33, v32
v_pk_mul_f32 v[4:5], v[4:5], v[12:13]
v_pk_mul_f32 v[6:7], v[6:7], v[12:13]
v_pk_mul_f32 v[8:9], v[8:9], v[16:17]
v_pk_mul_f32 v[10:11], v[10:11], v[16:17]
v_pk_mul_f32 v[20:21], v[20:21], v[28:29]
v_pk_mul_f32 v[22:23], v[22:23], v[28:29]
v_pk_mul_f32 v[24:25], v[24:25], v[32:33]
v_pk_mul_f32 v[26:27], v[26:27], v[32:33]
v_cvt_pk_bf16_f32 v36, v4, v5
v_cvt_pk_bf16_f32 v37, v6, v7
v_cvt_pk_bf16_f32 v38, v8, v9
v_cvt_pk_bf16_f32 v39, v10, v11
s_add_u32 s60, s13, 6
s_lshl_b32 s60, s60, 4
s_add_u32 s60, s60, s12
s_lshl_b32 s60, s60, 10
s_add_u32 s60, s60, 12058624
buffer_store_dwordx4 v[36:39], v114, s[48:51], s60 offen offset:0 sc1
v_cvt_pk_bf16_f32 v40, v20, v21
v_cvt_pk_bf16_f32 v41, v22, v23
v_cvt_pk_bf16_f32 v42, v24, v25
v_cvt_pk_bf16_f32 v43, v26, v27
s_add_u32 s60, s13, 7
s_lshl_b32 s60, s60, 4
s_add_u32 s60, s60, s12
s_lshl_b32 s60, s60, 10
s_add_u32 s60, s60, 12058624
buffer_store_dwordx4 v[40:43], v114, s[48:51], s60 offen offset:0 sc1
oj_60:
v_lshlrev_b32 v114, 4, v0
s_mul_i32 s60, s8, 3
s_add_u32 s60, s60, s11
s_lshl_b32 s60, s60, 16
s_lshl_b32 s61, s7, 14
s_add_u32 s60, s60, s61
s_add_u32 s61, s60, 0
v_add_u32 v108, s61, v114
s_add_u32 s61, s60, 64512
v_add_u32 v109, s61, v114
s_add_u32 s61, s60, 129024
v_add_u32 v110, s61, v114
s_mul_i32 s60, s7, 6144
v_add_u32 v111, s60, v114
s_mul_i32 s70, s7, 6144
s_mul_i32 s61, s8, 3072
s_add_u32 s70, s70, s61
s_lshl_b32 s100, s5, 12
s_lshl_b32 s14, s8, 1
s_add_u32 s14, s14, s7
s_and_b32 s14, s14, 3
s_mov_b32 s40, s20
s_and_b32 s41, s21, 0xffff
s_mov_b32 s42, 0x80000
s_mov_b32 s43, 0x00020000
s_mov_b32 s44, s30
s_and_b32 s45, s31, 0xffff
s_mov_b32 s46, 0xac000
s_mov_b32 s47, 0x00020000
s_mov_b32 s56, s28
s_and_b32 s57, s29, 0xffff
s_mov_b32 s58, 0x1000
s_mov_b32 s59, 0x00020000
v_lshrrev_b32 v112, 3, v0
v_and_b32 v113, 7, v0
v_lshrrev_b32 v114, 4, v0
v_lshrrev_b32 v115, 1, v113
v_xor_b32 v115, v115, v114
v_lshlrev_b32 v115, 5, v115
v_and_b32 v116, 1, v0
v_lshl_add_u32 v115, v116, 4, v115
v_lshl_add_u32 v115, v112, 10, v115
s_lshl_b32 s60, s98, 7
s_lshl_b32 s61, s6, 13
s_add_u32 s60, s60, s61
v_add_u32 v104, s60, v115
v_and_b32 v116, 15, v0
v_lshrrev_b32 v117, 2, v116
v_lshl_add_u32 v117, v114, 2, v117
v_lshrrev_b32 v118, 1, v117
v_and_b32 v118, 3, v118
v_and_b32 v116, 3, v116
v_lshlrev_b32 v116, 3, v116
v_lshl_add_u32 v116, v117, 7, v116
v_xor_b32 v119, 0, v118
v_lshl_add_u32 v100, v119, 5, v116
v_xor_b32 v119, 1, v118
v_lshl_add_u32 v101, v119, 5, v116
v_xor_b32 v119, 2, v118
v_lshl_add_u32 v102, v119, 5, v116
v_xor_b32 v119, 3, v118
v_lshl_add_u32 v103, v119, 5, v116
s_cmp_lg_u32 s6, 0
s_cbranch_scc1 if_64
s_lshl_b32 s60, s10, 8
s_add_u32 s60, s60, 15732736
s_mov_b64 s[68:69], exec
v_mov_b32 v121, 0
v_mov_b32 v122, 0
v_writelane_b32 v121, s60, 0
s_movk_i32 s64, 16
v_writelane_b32 v122, s64, 0
s_mov_b64 exec, 1
s_mov_b32 s65, 0
pz2_65:
buffer_load_dword v120, v121, s[48:51], 0 offen sc1
s_waitcnt vmcnt(0)
v_cmp_lt_u32 vcc, v120, v122
s_add_u32 s65, s65, 1
s_cmp_lt_u32 s65, 100000
s_cbranch_scc0 pz2ok_66
s_nop 1
s_cbranch_vccz pz2ok_66
s_sleep 1
s_branch pz2_65
pz2ok_66:
s_mov_b64 exec, s[68:69]
if_64:
s_barrier
s_cmp_eq_u32 s10, 7
s_cbranch_scc1 p2left_67
s_add_u32 m0, s70, 0
s_add_u32 s99, s100, 0
s_and_b32 s99, s99, 0x3fff
buffer_load_dwordx4 v108, s[48:51], s99 offen offset:0 sc1 lds
buffer_load_dwordx4 v109, s[48:51], s99 offen offset:1024 sc1 lds
buffer_load_dwordx4 v110, s[48:51], s99 offen offset:2048 sc1 lds
s_add_u32 m0, s70, 24576
s_add_u32 s99, s100, 1024
s_and_b32 s99, s99, 0x3fff
buffer_load_dwordx4 v108, s[48:51], s99 offen offset:0 sc1 lds
buffer_load_dwordx4 v109, s[48:51], s99 offen offset:1024 sc1 lds
buffer_load_dwordx4 v110, s[48:51], s99 offen offset:2048 sc1 lds
s_add_u32 m0, s70, 49152
s_add_u32 s99, s100, 2048
s_and_b32 s99, s99, 0x3fff
buffer_load_dwordx4 v108, s[48:51], s99 offen offset:0 sc1 lds
buffer_load_dwordx4 v109, s[48:51], s99 offen offset:1024 sc1 lds
buffer_load_dwordx4 v110, s[48:51], s99 offen offset:2048 sc1 lds
s_add_u32 m0, s70, 73728
s_add_u32 s99, s100, 3072
s_and_b32 s99, s99, 0x3fff
buffer_load_dwordx4 v108, s[48:51], s99 offen offset:0 sc1 lds
buffer_load_dwordx4 v109, s[48:51], s99 offen offset:1024 sc1 lds
buffer_load_dwordx4 v110, s[48:51], s99 offen offset:2048 sc1 lds
s_waitcnt vmcnt(9)
s_barrier
ds_read_b128 v[52:55], v111 offset:0
ds_read_b128 v[56:59], v111 offset:1024
ds_read_b128 v[60:63], v111 offset:2048
ds_read_b128 v[64:67], v111 offset:3072
ds_read_b128 v[68:71], v111 offset:4096
ds_read_b128 v[72:75], v111 offset:5120
s_add_u32 m0, s70, 98304
s_add_u32 s99, s100, 4096
s_and_b32 s99, s99, 0x3fff
buffer_load_dwordx4 v108, s[48:51], s99 offen offset:0 sc1 lds
buffer_load_dwordx4 v109, s[48:51], s99 offen offset:1024 sc1 lds
buffer_load_dwordx4 v110, s[48:51], s99 offen offset:2048 sc1 lds
s_waitcnt lgkmcnt(0)
s_waitcnt vmcnt(9)
s_barrier
v_mfma_f32_16x16x32_bf16 v[4:7], v[52:55], a[0:3], 0
ds_read_b128 v[76:79], v111 offset:24576
ds_read_b128 v[80:83], v111 offset:25600
v_mfma_f32_16x16x32_bf16 v[28:31], v[52:55], a[64:67], 0
ds_read_b128 v[84:87], v111 offset:26624
ds_read_b128 v[88:91], v111 offset:27648
v_mfma_f32_16x16x32_bf16 v[8:11], v[56:59], a[0:3], 0
ds_read_b128 v[92:95], v111 offset:28672
ds_read_b128 v[96:99], v111 offset:29696
s_add_u32 m0, s70, 122880
s_add_u32 s99, s100, 5120
s_and_b32 s99, s99, 0x3fff
buffer_load_dwordx4 v108, s[48:51], s99 offen offset:0 sc1 lds
v_mfma_f32_16x16x32_bf16 v[32:35], v[56:59], a[64:67], 0
v_mfma_f32_16x16x32_bf16 v[12:15], v[60:63], a[0:3], 0
v_mfma_f32_16x16x32_bf16 v[36:39], v[60:63], a[64:67], 0
v_mfma_f32_16x16x32_bf16 v[16:19], v[64:67], a[0:3], 0
buffer_load_dwordx4 v109, s[48:51], s99 offen offset:1024 sc1 lds
v_mfma_f32_16x16x32_bf16 v[40:43], v[64:67], a[64:67], 0
v_mfma_f32_16x16x32_bf16 v[20:23], v[68:71], a[0:3], 0
v_mfma_f32_16x16x32_bf16 v[44:47], v[68:71], a[64:67], 0
v_mfma_f32_16x16x32_bf16 v[24:27], v[72:75], a[0:3], 0
buffer_load_dwordx4 v110, s[48:51], s99 offen offset:2048 sc1 lds
v_mfma_f32_16x16x32_bf16 v[48:51], v[72:75], a[64:67], 0
s_waitcnt lgkmcnt(0)
s_waitcnt vmcnt(9)
s_barrier
v_mfma_f32_16x16x32_bf16 v[4:7], v[76:79], a[4:7], v[4:7]
ds_read_b128 v[52:55], v111 offset:49152
ds_read_b128 v[56:59], v111 offset:50176
v_mfma_f32_16x16x32_bf16 v[28:31], v[76:79], a[68:71], v[28:31]
ds_read_b128 v[60:63], v111 offset:51200
ds_read_b128 v[64:67], v111 offset:52224
v_mfma_f32_16x16x32_bf16 v[8:11], v[80:83], a[4:7], v[8:11]
ds_read_b128 v[68:71], v111 offset:53248
ds_read_b128 v[72:75], v111 offset:54272
s_add_u32 m0, s70, 0
s_add_u32 s99, s100, 6144
s_and_b32 s99, s99, 0x3fff
buffer_load_dwordx4 v108, s[48:51], s99 offen offset:0 sc1 lds
v_mfma_f32_16x16x32_bf16 v[32:35], v[80:83], a[68:71], v[32:35]
v_mfma_f32_16x16x32_bf16 v[12:15], v[84:87], a[4:7], v[12:15]
v_mfma_f32_16x16x32_bf16 v[36:39], v[84:87], a[68:71], v[36:39]
v_mfma_f32_16x16x32_bf16 v[16:19], v[88:91], a[4:7], v[16:19]
buffer_load_dwordx4 v109, s[48:51], s99 offen offset:1024 sc1 lds
v_mfma_f32_16x16x32_bf16 v[40:43], v[88:91], a[68:71], v[40:43]
v_mfma_f32_16x16x32_bf16 v[20:23], v[92:95], a[4:7], v[20:23]
v_mfma_f32_16x16x32_bf16 v[44:47], v[92:95], a[68:71], v[44:47]
v_mfma_f32_16x16x32_bf16 v[24:27], v[96:99], a[4:7], v[24:27]
buffer_load_dwordx4 v110, s[48:51], s99 offen offset:2048 sc1 lds
v_mfma_f32_16x16x32_bf16 v[48:51], v[96:99], a[68:71], v[48:51]
s_waitcnt lgkmcnt(0)
s_waitcnt vmcnt(9)
s_barrier
v_add_u32 v114, 73728, v111
v_mfma_f32_16x16x32_bf16 v[4:7], v[52:55], a[8:11], v[4:7]
ds_read_b128 v[76:79], v114 offset:0
ds_read_b128 v[80:83], v114 offset:1024
v_mfma_f32_16x16x32_bf16 v[28:31], v[52:55], a[72:75], v[28:31]
ds_read_b128 v[84:87], v114 offset:2048
ds_read_b128 v[88:91], v114 offset:3072
v_mfma_f32_16x16x32_bf16 v[8:11], v[56:59], a[8:11], v[8:11]
ds_read_b128 v[92:95], v114 offset:4096
ds_read_b128 v[96:99], v114 offset:5120
s_add_u32 m0, s70, 24576
s_add_u32 s99, s100, 7168
s_and_b32 s99, s99, 0x3fff
buffer_load_dwordx4 v108, s[48:51], s99 offen offset:0 sc1 lds
v_mfma_f32_16x16x32_bf16 v[32:35], v[56:59], a[72:75], v[32:35]
v_mfma_f32_16x16x32_bf16 v[12:15], v[60:63], a[8:11], v[12:15]
v_mfma_f32_16x16x32_bf16 v[36:39], v[60:63], a[72:75], v[36:39]
v_mfma_f32_16x16x32_bf16 v[16:19], v[64:67], a[8:11], v[16:19]
buffer_load_dwordx4 v109, s[48:51], s99 offen offset:1024 sc1 lds
v_mfma_f32_16x16x32_bf16 v[40:43], v[64:67], a[72:75], v[40:43]
v_mfma_f32_16x16x32_bf16 v[20:23], v[68:71], a[8:11], v[20:23]
v_mfma_f32_16x16x32_bf16 v[44:47], v[68:71], a[72:75], v[44:47]
v_mfma_f32_16x16x32_bf16 v[24:27], v[72:75], a[8:11], v[24:27]
buffer_load_dwordx4 v110, s[48:51], s99 offen offset:2048 sc1 lds
v_mfma_f32_16x16x32_bf16 v[48:51], v[72:75], a[72:75], v[48:51]
s_waitcnt lgkmcnt(0)
s_waitcnt vmcnt(9)
s_barrier
v_add_u32 v114, 98304, v111
v_mfma_f32_16x16x32_bf16 v[4:7], v[76:79], a[12:15], v[4:7]
ds_read_b128 v[52:55], v114 offset:0
ds_read_b128 v[56:59], v114 offset:1024
v_mfma_f32_16x16x32_bf16 v[28:31], v[76:79], a[76:79], v[28:31]
ds_read_b128 v[60:63], v114 offset:2048
ds_read_b128 v[64:67], v114 offset:3072
v_mfma_f32_16x16x32_bf16 v[8:11], v[80:83], a[12:15], v[8:11]
ds_read_b128 v[68:71], v114 offset:4096
ds_read_b128 v[72:75], v114 offset:5120
s_add_u32 m0, s70, 49152
s_add_u32 s99, s100, 8192
s_and_b32 s99, s99, 0x3fff
buffer_load_dwordx4 v108, s[48:51], s99 offen offset:0 sc1 lds
v_mfma_f32_16x16x32_bf16 v[32:35], v[80:83], a[76:79], v[32:35]
v_mfma_f32_16x16x32_bf16 v[12:15], v[84:87], a[12:15], v[12:15]
v_mfma_f32_16x16x32_bf16 v[36:39], v[84:87], a[76:79], v[36:39]
v_mfma_f32_16x16x32_bf16 v[16:19], v[88:91], a[12:15], v[16:19]
buffer_load_dwordx4 v109, s[48:51], s99 offen offset:1024 sc1 lds
v_mfma_f32_16x16x32_bf16 v[40:43], v[88:91], a[76:79], v[40:43]
v_mfma_f32_16x16x32_bf16 v[20:23], v[92:95], a[12:15], v[20:23]
v_mfma_f32_16x16x32_bf16 v[44:47], v[92:95], a[76:79], v[44:47]
v_mfma_f32_16x16x32_bf16 v[24:27], v[96:99], a[12:15], v[24:27]
buffer_load_dwordx4 v110, s[48:51], s99 offen offset:2048 sc1 lds
v_mfma_f32_16x16x32_bf16 v[48:51], v[96:99], a[76:79], v[48:51]
s_waitcnt lgkmcnt(0)
s_waitcnt vmcnt(9)
s_barrier
v_add_u32 v114, 122880, v111
s_cmp_lg_u32 s6, 0
s_cbranch_scc1 if_69
s_lshl_b32 s60, s10, 8
s_add_u32 s60, s60, 15747072
s_add_u32 s61, s10, 1
s_and_b32 s61, s61, 7
s_lshl_b32 s61, s61, 8
s_add_u32 s61, s61, 15747072
v_mov_b32 v113, 15748864
v_writelane_b32 v113, s60, 0
v_writelane_b32 v113, s61, 1
buffer_load_dword v105, v113, s[48:51], 0 offen sc1
if_69:
v_mfma_f32_16x16x32_bf16 v[4:7], v[52:55], a[16:19], v[4:7]
ds_read_b128 v[76:79], v114 offset:0
ds_read_b128 v[80:83], v114 offset:1024
v_mfma_f32_16x16x32_bf16 v[28:31], v[52:55], a[80:83], v[28:31]
ds_read_b128 v[84:87], v114 offset:2048
ds_read_b128 v[88:91], v114 offset:3072
v_mfma_f32_16x16x32_bf16 v[8:11], v[56:59], a[16:19], v[8:11]
ds_read_b128 v[92:95], v114 offset:4096
ds_read_b128 v[96:99], v114 offset:5120
s_add_u32 m0, s70, 73728
s_add_u32 s99, s100, 9216
s_and_b32 s99, s99, 0x3fff
buffer_load_dwordx4 v108, s[48:51], s99 offen offset:0 sc1 lds
v_mfma_f32_16x16x32_bf16 v[32:35], v[56:59], a[80:83], v[32:35]
v_mfma_f32_16x16x32_bf16 v[12:15], v[60:63], a[16:19], v[12:15]
v_mfma_f32_16x16x32_bf16 v[36:39], v[60:63], a[80:83], v[36:39]
v_mfma_f32_16x16x32_bf16 v[16:19], v[64:67], a[16:19], v[16:19]
buffer_load_dwordx4 v109, s[48:51], s99 offen offset:1024 sc1 lds
v_mfma_f32_16x16x32_bf16 v[40:43], v[64:67], a[80:83], v[40:43]
v_mfma_f32_16x16x32_bf16 v[20:23], v[68:71], a[16:19], v[20:23]
v_mfma_f32_16x16x32_bf16 v[44:47], v[68:71], a[80:83], v[44:47]
v_mfma_f32_16x16x32_bf16 v[24:27], v[72:75], a[16:19], v[24:27]
buffer_load_dwordx4 v110, s[48:51], s99 offen offset:2048 sc1 lds
v_mfma_f32_16x16x32_bf16 v[48:51], v[72:75], a[80:83], v[48:51]
s_waitcnt lgkmcnt(0)
s_waitcnt vmcnt(9)
s_barrier
v_mfma_f32_16x16x32_bf16 v[4:7], v[76:79], a[20:23], v[4:7]
ds_read_b128 v[52:55], v111 offset:0
ds_read_b128 v[56:59], v111 offset:1024
v_mfma_f32_16x16x32_bf16 v[28:31], v[76:79], a[84:87], v[28:31]
ds_read_b128 v[60:63], v111 offset:2048
ds_read_b128 v[64:67], v111 offset:3072
v_mfma_f32_16x16x32_bf16 v[8:11], v[80:83], a[20:23], v[8:11]
ds_read_b128 v[68:71], v111 offset:4096
ds_read_b128 v[72:75], v111 offset:5120
s_add_u32 m0, s70, 98304
s_add_u32 s99, s100, 10240
s_and_b32 s99, s99, 0x3fff
buffer_load_dwordx4 v108, s[48:51], s99 offen offset:0 sc1 lds
v_mfma_f32_16x16x32_bf16 v[32:35], v[80:83], a[84:87], v[32:35]
v_mfma_f32_16x16x32_bf16 v[12:15], v[84:87], a[20:23], v[12:15]
v_mfma_f32_16x16x32_bf16 v[36:39], v[84:87], a[84:87], v[36:39]
v_mfma_f32_16x16x32_bf16 v[16:19], v[88:91], a[20:23], v[16:19]
buffer_load_dwordx4 v109, s[48:51], s99 offen offset:1024 sc1 lds
v_mfma_f32_16x16x32_bf16 v[40:43], v[88:91], a[84:87], v[40:43]
v_mfma_f32_16x16x32_bf16 v[20:23], v[92:95], a[20:23], v[20:23]
v_mfma_f32_16x16x32_bf16 v[44:47], v[92:95], a[84:87], v[44:47]
v_mfma_f32_16x16x32_bf16 v[24:27], v[96:99], a[20:23], v[24:27]
buffer_load_dwordx4 v110, s[48:51], s99 offen offset:2048 sc1 lds
v_mfma_f32_16x16x32_bf16 v[48:51], v[96:99], a[84:87], v[48:51]
s_waitcnt lgkmcnt(0)
s_waitcnt vmcnt(9)
s_barrier
v_mfma_f32_16x16x32_bf16 v[4:7], v[52:55], a[24:27], v[4:7]
ds_read_b128 v[76:79], v111 offset:24576
ds_read_b128 v[80:83], v111 offset:25600
v_mfma_f32_16x16x32_bf16 v[28:31], v[52:55], a[88:91], v[28:31]
ds_read_b128 v[84:87], v111 offset:26624
ds_read_b128 v[88:91], v111 offset:27648
v_mfma_f32_16x16x32_bf16 v[8:11], v[56:59], a[24:27], v[8:11]
ds_read_b128 v[92:95], v111 offset:28672
ds_read_b128 v[96:99], v111 offset:29696
s_add_u32 m0, s70, 122880
s_add_u32 s99, s100, 11264
s_and_b32 s99, s99, 0x3fff
buffer_load_dwordx4 v108, s[48:51], s99 offen offset:0 sc1 lds
v_mfma_f32_16x16x32_bf16 v[32:35], v[56:59], a[88:91], v[32:35]
v_mfma_f32_16x16x32_bf16 v[12:15], v[60:63], a[24:27], v[12:15]
v_mfma_f32_16x16x32_bf16 v[36:39], v[60:63], a[88:91], v[36:39]
v_mfma_f32_16x16x32_bf16 v[16:19], v[64:67], a[24:27], v[16:19]
buffer_load_dwordx4 v109, s[48:51], s99 offen offset:1024 sc1 lds
v_mfma_f32_16x16x32_bf16 v[40:43], v[64:67], a[88:91], v[40:43]
v_mfma_f32_16x16x32_bf16 v[20:23], v[68:71], a[24:27], v[20:23]
v_mfma_f32_16x16x32_bf16 v[44:47], v[68:71], a[88:91], v[44:47]
v_mfma_f32_16x16x32_bf16 v[24:27], v[72:75], a[24:27], v[24:27]
buffer_load_dwordx4 v110, s[48:51], s99 offen offset:2048 sc1 lds
v_mfma_f32_16x16x32_bf16 v[48:51], v[72:75], a[88:91], v[48:51]
s_waitcnt lgkmcnt(0)
s_waitcnt vmcnt(9)
s_barrier
v_mfma_f32_16x16x32_bf16 v[4:7], v[76:79], a[28:31], v[4:7]
ds_read_b128 v[52:55], v111 offset:49152
ds_read_b128 v[56:59], v111 offset:50176
v_mfma_f32_16x16x32_bf16 v[28:31], v[76:79], a[92:95], v[28:31]
ds_read_b128 v[60:63], v111 offset:51200
ds_read_b128 v[64:67], v111 offset:52224
v_mfma_f32_16x16x32_bf16 v[8:11], v[80:83], a[28:31], v[8:11]
ds_read_b128 v[68:71], v111 offset:53248
ds_read_b128 v[72:75], v111 offset:54272
s_add_u32 m0, s70, 0
s_add_u32 s99, s100, 12288
s_and_b32 s99, s99, 0x3fff
buffer_load_dwordx4 v108, s[48:51], s99 offen offset:0 sc1 lds
v_mfma_f32_16x16x32_bf16 v[32:35], v[80:83], a[92:95], v[32:35]
v_mfma_f32_16x16x32_bf16 v[12:15], v[84:87], a[28:31], v[12:15]
v_mfma_f32_16x16x32_bf16 v[36:39], v[84:87], a[92:95], v[36:39]
v_mfma_f32_16x16x32_bf16 v[16:19], v[88:91], a[28:31], v[16:19]
buffer_load_dwordx4 v109, s[48:51], s99 offen offset:1024 sc1 lds
v_mfma_f32_16x16x32_bf16 v[40:43], v[88:91], a[92:95], v[40:43]
v_mfma_f32_16x16x32_bf16 v[20:23], v[92:95], a[28:31], v[20:23]
v_mfma_f32_16x16x32_bf16 v[44:47], v[92:95], a[92:95], v[44:47]
v_mfma_f32_16x16x32_bf16 v[24:27], v[96:99], a[28:31], v[24:27]
buffer_load_dwordx4 v110, s[48:51], s99 offen offset:2048 sc1 lds
v_mfma_f32_16x16x32_bf16 v[48:51], v[96:99], a[92:95], v[48:51]
s_waitcnt lgkmcnt(0)
s_waitcnt vmcnt(9)
s_barrier
v_add_u32 v114, 73728, v111
v_mfma_f32_16x16x32_bf16 v[4:7], v[52:55], a[32:35], v[4:7]
ds_read_b128 v[76:79], v114 offset:0
ds_read_b128 v[80:83], v114 offset:1024
v_mfma_f32_16x16x32_bf16 v[28:31], v[52:55], a[96:99], v[28:31]
ds_read_b128 v[84:87], v114 offset:2048
ds_read_b128 v[88:91], v114 offset:3072
v_mfma_f32_16x16x32_bf16 v[8:11], v[56:59], a[32:35], v[8:11]
ds_read_b128 v[92:95], v114 offset:4096
ds_read_b128 v[96:99], v114 offset:5120
s_add_u32 m0, s70, 24576
s_add_u32 s99, s100, 13312
s_and_b32 s99, s99, 0x3fff
buffer_load_dwordx4 v108, s[48:51], s99 offen offset:0 sc1 lds
v_mfma_f32_16x16x32_bf16 v[32:35], v[56:59], a[96:99], v[32:35]
v_mfma_f32_16x16x32_bf16 v[12:15], v[60:63], a[32:35], v[12:15]
v_mfma_f32_16x16x32_bf16 v[36:39], v[60:63], a[96:99], v[36:39]
v_mfma_f32_16x16x32_bf16 v[16:19], v[64:67], a[32:35], v[16:19]
buffer_load_dwordx4 v109, s[48:51], s99 offen offset:1024 sc1 lds
v_mfma_f32_16x16x32_bf16 v[40:43], v[64:67], a[96:99], v[40:43]
v_mfma_f32_16x16x32_bf16 v[20:23], v[68:71], a[32:35], v[20:23]
v_mfma_f32_16x16x32_bf16 v[44:47], v[68:71], a[96:99], v[44:47]
v_mfma_f32_16x16x32_bf16 v[24:27], v[72:75], a[32:35], v[24:27]
buffer_load_dwordx4 v110, s[48:51], s99 offen offset:2048 sc1 lds
v_mfma_f32_16x16x32_bf16 v[48:51], v[72:75], a[96:99], v[48:51]
s_waitcnt lgkmcnt(0)
s_waitcnt vmcnt(9)
s_barrier
v_add_u32 v114, 98304, v111
s_cmp_lg_u32 s6, 0
s_cbranch_scc1 if_70
v_cmp_gt_u32 vcc, 16, v105
s_nop 4
s_cbranch_vccz zd_71
s_lshl_b32 s60, s10, 8
s_add_u32 s60, s60, 15747072
s_add_u32 s61, s10, 1
s_and_b32 s61, s61, 7
s_lshl_b32 s61, s61, 8
s_add_u32 s61, s61, 15747072
s_mov_b32 s62, 15748864
s_mov_b64 s[68:69], exec
v_mov_b32 v117, 0
v_mov_b32 v118, 0
v_writelane_b32 v117, s60, 0
s_movk_i32 s64, 16
v_writelane_b32 v118, s64, 0
v_writelane_b32 v117, s61, 1
s_movk_i32 s64, 16
v_writelane_b32 v118, s64, 1
v_writelane_b32 v117, s62, 2
s_movk_i32 s64, 16
v_writelane_b32 v118, s64, 2
s_mov_b64 exec, 7
s_mov_b32 s65, 0
pz1_72:
buffer_load_dword v116, v117, s[48:51], 0 offen sc1
s_waitcnt vmcnt(0)
v_cmp_lt_u32 vcc, v116, v118
s_add_u32 s65, s65, 1
s_cmp_lt_u32 s65, 100000
s_cbranch_scc0 pz1ok_73
s_nop 1
s_cbranch_vccz pz1ok_73
s_sleep 1
s_branch pz1_72
pz1ok_73:
s_mov_b64 exec, s[68:69]
zd_71:
if_70:
v_mfma_f32_16x16x32_bf16 v[4:7], v[76:79], a[36:39], v[4:7]
ds_read_b128 v[52:55], v114 offset:0
ds_read_b128 v[56:59], v114 offset:1024
v_mfma_f32_16x16x32_bf16 v[28:31], v[76:79], a[100:103], v[28:31]
ds_read_b128 v[60:63], v114 offset:2048
ds_read_b128 v[64:67], v114 offset:3072
v_mfma_f32_16x16x32_bf16 v[8:11], v[80:83], a[36:39], v[8:11]
ds_read_b128 v[68:71], v114 offset:4096
ds_read_b128 v[72:75], v114 offset:5120
s_add_u32 m0, s70, 49152
s_add_u32 s99, s100, 14336
s_and_b32 s99, s99, 0x3fff
buffer_load_dwordx4 v108, s[48:51], s99 offen offset:0 sc1 lds
v_mfma_f32_16x16x32_bf16 v[32:35], v[80:83], a[100:103], v[32:35]
v_mfma_f32_16x16x32_bf16 v[12:15], v[84:87], a[36:39], v[12:15]
v_mfma_f32_16x16x32_bf16 v[36:39], v[84:87], a[100:103], v[36:39]
v_mfma_f32_16x16x32_bf16 v[16:19], v[88:91], a[36:39], v[16:19]
buffer_load_dwordx4 v109, s[48:51], s99 offen offset:1024 sc1 lds
v_mfma_f32_16x16x32_bf16 v[40:43], v[88:91], a[100:103], v[40:43]
v_mfma_f32_16x16x32_bf16 v[20:23], v[92:95], a[36:39], v[20:23]
v_mfma_f32_16x16x32_bf16 v[44:47], v[92:95], a[100:103], v[44:47]
v_mfma_f32_16x16x32_bf16 v[24:27], v[96:99], a[36:39], v[24:27]
buffer_load_dwordx4 v110, s[48:51], s99 offen offset:2048 sc1 lds
v_mfma_f32_16x16x32_bf16 v[48:51], v[96:99], a[100:103], v[48:51]
s_waitcnt lgkmcnt(0)
s_waitcnt vmcnt(9)
s_barrier
v_add_u32 v114, 122880, v111
v_mfma_f32_16x16x32_bf16 v[4:7], v[52:55], a[40:43], v[4:7]
ds_read_b128 v[76:79], v114 offset:0
ds_read_b128 v[80:83], v114 offset:1024
v_mfma_f32_16x16x32_bf16 v[28:31], v[52:55], a[104:107], v[28:31]
ds_read_b128 v[84:87], v114 offset:2048
ds_read_b128 v[88:91], v114 offset:3072
s_add_u32 m0, s70, 73728
s_add_u32 s99, s100, 15360
s_and_b32 s99, s99, 0x3fff
buffer_load_dwordx4 v108, s[48:51], s99 offen offset:0 sc1 lds
v_mfma_f32_16x16x32_bf16 v[8:11], v[56:59], a[40:43], v[8:11]
ds_read_b128 v[92:95], v114 offset:4096
ds_read_b128 v[96:99], v114 offset:5120
v_mfma_f32_16x16x32_bf16 v[32:35], v[56:59], a[104:107], v[32:35]
v_mfma_f32_16x16x32_bf16 v[12:15], v[60:63], a[40:43], v[12:15]
buffer_load_dwordx4 v109, s[48:51], s99 offen offset:1024 sc1 lds
v_mfma_f32_16x16x32_bf16 v[36:39], v[60:63], a[104:107], v[36:39]
v_mfma_f32_16x16x32_bf16 v[16:19], v[64:67], a[40:43], v[16:19]
v_mfma_f32_16x16x32_bf16 v[40:43], v[64:67], a[104:107], v[40:43]
buffer_load_dwordx4 v110, s[48:51], s99 offen offset:2048 sc1 lds
v_mfma_f32_16x16x32_bf16 v[20:23], v[68:71], a[40:43], v[20:23]
v_mfma_f32_16x16x32_bf16 v[44:47], v[68:71], a[104:107], v[44:47]
v_mfma_f32_16x16x32_bf16 v[24:27], v[72:75], a[40:43], v[24:27]
s_add_u32 s60, s14, 0
s_cmp_ge_u32 s60, 3
s_cselect_b32 s61, 1, 0
s_mul_i32 s62, s61, 3
s_sub_u32 s12, s60, s62
s_lshl_b32 s63, s9, 2
s_lshl_b32 s64, s8, 1
s_add_u32 s63, s63, s64
s_add_u32 s72, s63, s61
s_lshr_b32 s63, s72, 1
s_mul_i32 s64, s63, 43
s_add_u32 s64, s64, s11
s_lshl_b32 s62, s12, 1
s_add_u32 s64, s64, s62
s_lshl_b32 s64, s64, 10
s_add_u32 s64, s64, 3145728
s_and_b32 s63, s72, 1
s_lshl_b32 s63, s63, 3
s_add_u32 s64, s64, s63
v_lshlrev_b32 v115, 4, v0
buffer_load_dwordx2 v[116:117], v115, s[48:51], s64 offen sc1
buffer_load_dwordx2 v[118:119], v115, s[48:51], s64 offen offset:1024 sc1
v_and_b32 v126, 15, v0
v_lshlrev_b32 v115, 2, v126
s_lshl_b32 s64, s72, 6
s_add_u32 s64, s64, 15335424
buffer_load_dword v120, v115, s[48:51], s64 offen sc1
v_lshlrev_b32 v126, 1, v126
s_lshl_b32 s64, s72, 5
buffer_load_ushort v121, v126, s[56:59], s64 offen
v_mfma_f32_16x16x32_bf16 v[48:51], v[72:75], a[104:107], v[48:51]
s_waitcnt lgkmcnt(0)
s_waitcnt vmcnt(13)
s_barrier
v_mfma_f32_16x16x32_bf16 v[4:7], v[76:79], a[44:47], v[4:7]
ds_read_b128 v[52:55], v111 offset:0
ds_read_b128 v[56:59], v111 offset:1024
v_mfma_f32_16x16x32_bf16 v[28:31], v[76:79], a[108:111], v[28:31]
ds_read_b128 v[60:63], v111 offset:2048
ds_read_b128 v[64:67], v111 offset:3072
v_mfma_f32_16x16x32_bf16 v[8:11], v[80:83], a[44:47], v[8:11]
ds_read_b128 v[68:71], v111 offset:4096
ds_read_b128 v[72:75], v111 offset:5120
v_mfma_f32_16x16x32_bf16 v[32:35], v[80:83], a[108:111], v[32:35]
v_mfma_f32_16x16x32_bf16 v[12:15], v[84:87], a[44:47], v[12:15]
v_mfma_f32_16x16x32_bf16 v[36:39], v[84:87], a[108:111], v[36:39]
v_mfma_f32_16x16x32_bf16 v[16:19], v[88:91], a[44:47], v[16:19]
s_add_u32 s60, s14, 4
s_cmp_ge_u32 s60, 6
s_cselect_b32 s60, s14, s60
s_cmp_ge_u32 s60, 3
s_cselect_b32 s61, 1, 0
s_mul_i32 s62, s61, 3
s_sub_u32 s13, s60, s62
s_lshl_b32 s63, s9, 2
s_lshl_b32 s64, s8, 1
s_add_u32 s63, s63, s64
s_add_u32 s73, s63, s61
s_lshr_b32 s63, s73, 1
s_mul_i32 s64, s63, 43
s_add_u32 s64, s64, s11
s_lshl_b32 s62, s13, 1
s_add_u32 s64, s64, s62
s_lshl_b32 s64, s64, 10
s_add_u32 s64, s64, 3145728
s_and_b32 s63, s73, 1
s_lshl_b32 s63, s63, 3
s_add_u32 s64, s64, s63
v_lshlrev_b32 v115, 4, v0
buffer_load_dwordx2 v[122:123], v115, s[48:51], s64 offen sc1
buffer_load_dwordx2 v[124:125], v115, s[48:51], s64 offen offset:1024 sc1
v_and_b32 v126, 15, v0
v_lshlrev_b32 v115, 2, v126
s_lshl_b32 s64, s73, 6
s_add_u32 s64, s64, 15335424
buffer_load_dword v112, v115, s[48:51], s64 offen sc1
v_lshlrev_b32 v126, 1, v126
s_lshl_b32 s64, s73, 5
buffer_load_ushort v113, v126, s[56:59], s64 offen
v_mfma_f32_16x16x32_bf16 v[40:43], v[88:91], a[108:111], v[40:43]
v_mfma_f32_16x16x32_bf16 v[20:23], v[92:95], a[44:47], v[20:23]
v_mfma_f32_16x16x32_bf16 v[44:47], v[92:95], a[108:111], v[44:47]
v_mfma_f32_16x16x32_bf16 v[24:27], v[96:99], a[44:47], v[24:27]
v_mfma_f32_16x16x32_bf16 v[48:51], v[96:99], a[108:111], v[48:51]
s_waitcnt lgkmcnt(0)
s_waitcnt vmcnt(14)
s_barrier
v_mfma_f32_16x16x32_bf16 v[4:7], v[52:55], a[48:51], v[4:7]
ds_read_b128 v[76:79], v111 offset:24576
ds_read_b128 v[80:83], v111 offset:25600
v_mfma_f32_16x16x32_bf16 v[28:31], v[52:55], a[112:115], v[28:31]
ds_read_b128 v[84:87], v111 offset:26624
ds_read_b128 v[88:91], v111 offset:27648
v_mfma_f32_16x16x32_bf16 v[8:11], v[56:59], a[48:51], v[8:11]
ds_read_b128 v[92:95], v111 offset:28672
ds_read_b128 v[96:99], v111 offset:29696
s_add_u32 m0, s75, 0
s_mov_b32 s66, 0
buffer_load_dwordx4 v104, s[40:43], s66 offen  lds
v_mfma_f32_16x16x32_bf16 v[32:35], v[56:59], a[112:115], v[32:35]
v_mfma_f32_16x16x32_bf16 v[12:15], v[60:63], a[48:51], v[12:15]
v_mfma_f32_16x16x32_bf16 v[36:39], v[60:63], a[112:115], v[36:39]
v_mfma_f32_16x16x32_bf16 v[16:19], v[64:67], a[48:51], v[16:19]
s_add_u32 m0, s75, 8192
s_mov_b32 s66, 65536
buffer_load_dwordx4 v104, s[40:43], s66 offen  lds
v_mfma_f32_16x16x32_bf16 v[40:43], v[64:67], a[112:115], v[40:43]
v_mfma_f32_16x16x32_bf16 v[20:23], v[68:71], a[48:51], v[20:23]
v_mfma_f32_16x16x32_bf16 v[44:47], v[68:71], a[112:115], v[44:47]
v_mfma_f32_16x16x32_bf16 v[24:27], v[72:75], a[48:51], v[24:27]
s_add_u32 m0, s75, 16384
s_mov_b32 s66, 131072
buffer_load_dwordx4 v104, s[40:43], s66 offen  lds
v_mfma_f32_16x16x32_bf16 v[48:51], v[72:75], a[112:115], v[48:51]
s_waitcnt lgkmcnt(0)
s_waitcnt vmcnt(14)
s_barrier
v_mfma_f32_16x16x32_bf16 v[4:7], v[76:79], a[52:55], v[4:7]
ds_read_b128 v[52:55], v111 offset:49152
ds_read_b128 v[56:59], v111 offset:50176
v_mfma_f32_16x16x32_bf16 v[28:31], v[76:79], a[116:119], v[28:31]
ds_read_b128 v[60:63], v111 offset:51200
ds_read_b128 v[64:67], v111 offset:52224
v_mfma_f32_16x16x32_bf16 v[8:11], v[80:83], a[52:55], v[8:11]
ds_read_b128 v[68:71], v111 offset:53248
ds_read_b128 v[72:75], v111 offset:54272
s_add_u32 m0, s75, 24576
s_mov_b32 s66, 196608
buffer_load_dwordx4 v104, s[40:43], s66 offen  lds
v_mfma_f32_16x16x32_bf16 v[32:35], v[80:83], a[116:119], v[32:35]
v_mfma_f32_16x16x32_bf16 v[12:15], v[84:87], a[52:55], v[12:15]
v_mfma_f32_16x16x32_bf16 v[36:39], v[84:87], a[116:119], v[36:39]
v_mfma_f32_16x16x32_bf16 v[16:19], v[88:91], a[52:55], v[16:19]
s_add_u32 m0, s75, 32768
s_mov_b32 s66, 262144
buffer_load_dwordx4 v104, s[40:43], s66 offen  lds
v_mfma_f32_16x16x32_bf16 v[40:43], v[88:91], a[116:119], v[40:43]
v_mfma_f32_16x16x32_bf16 v[20:23], v[92:95], a[52:55], v[20:23]
v_mfma_f32_16x16x32_bf16 v[44:47], v[92:95], a[116:119], v[44:47]
v_mfma_f32_16x16x32_bf16 v[24:27], v[96:99], a[52:55], v[24:27]
s_add_u32 m0, s75, 40960
s_mov_b32 s66, 327680
buffer_load_dwordx4 v104, s[40:43], s66 offen  lds
v_mfma_f32_16x16x32_bf16 v[48:51], v[96:99], a[116:119], v[48:51]
s_waitcnt lgkmcnt(0)
s_waitcnt vmcnt(14)
s_barrier
v_add_u32 v114, 73728, v111
s_cmp_lg_u32 s6, 0
s_cbranch_scc1 if_74
s_lshr_b32 s61, s97, 4
s_lshl_b32 s61, s61, 2
s_and_b32 s62, s97, 3
s_add_u32 s61, s61, s62
s_lshl_b32 s61, s61, 8
s_add_u32 s61, s61, 15745024
v_mov_b32 v1, 0
buffer_load_dword v105, v1, s[48:51], s61 offen sc1
if_74:
v_mfma_f32_16x16x32_bf16 v[4:7], v[52:55], a[56:59], v[4:7]
ds_read_b128 v[76:79], v114 offset:0
ds_read_b128 v[80:83], v114 offset:1024
v_mfma_f32_16x16x32_bf16 v[28:31], v[52:55], a[120:123], v[28:31]
ds_read_b128 v[84:87], v114 offset:2048
ds_read_b128 v[88:91], v114 offset:3072
v_mfma_f32_16x16x32_bf16 v[8:11], v[56:59], a[56:59], v[8:11]
ds_read_b128 v[92:95], v114 offset:4096
ds_read_b128 v[96:99], v114 offset:5120
v_mfma_f32_16x16x32_bf16 v[32:35], v[56:59], a[120:123], v[32:35]
s_add_u32 m0, s75, 49152
s_mov_b32 s66, 393216
buffer_load_dwordx4 v104, s[40:43], s66 offen  lds
v_mfma_f32_16x16x32_bf16 v[12:15], v[60:63], a[56:59], v[12:15]
v_mfma_f32_16x16x32_bf16 v[36:39], v[60:63], a[120:123], v[36:39]
v_mfma_f32_16x16x32_bf16 v[16:19], v[64:67], a[56:59], v[16:19]
v_mfma_f32_16x16x32_bf16 v[40:43], v[64:67], a[120:123], v[40:43]
v_mfma_f32_16x16x32_bf16 v[20:23], v[68:71], a[56:59], v[20:23]
v_mfma_f32_16x16x32_bf16 v[44:47], v[68:71], a[120:123], v[44:47]
s_add_u32 m0, s75, 57344
s_mov_b32 s66, 458752
buffer_load_dwordx4 v104, s[40:43], s66 offen  lds
v_mfma_f32_16x16x32_bf16 v[24:27], v[72:75], a[56:59], v[24:27]
v_mfma_f32_16x16x32_bf16 v[48:51], v[72:75], a[120:123], v[48:51]
s_waitcnt lgkmcnt(0)
v_mfma_f32_16x16x32_bf16 v[4:7], v[76:79], a[60:63], v[4:7]
v_mfma_f32_16x16x32_bf16 v[28:31], v[76:79], a[124:127], v[28:31]
v_mfma_f32_16x16x32_bf16 v[8:11], v[80:83], a[60:63], v[8:11]
v_mfma_f32_16x16x32_bf16 v[32:35], v[80:83], a[124:127], v[32:35]
v_mfma_f32_16x16x32_bf16 v[12:15], v[84:87], a[60:63], v[12:15]
v_mfma_f32_16x16x32_bf16 v[36:39], v[84:87], a[124:127], v[36:39]
v_mfma_f32_16x16x32_bf16 v[16:19], v[88:91], a[60:63], v[16:19]
v_mfma_f32_16x16x32_bf16 v[40:43], v[88:91], a[124:127], v[40:43]
v_mfma_f32_16x16x32_bf16 v[20:23], v[92:95], a[60:63], v[20:23]
v_mfma_f32_16x16x32_bf16 v[44:47], v[92:95], a[124:127], v[44:47]
v_mfma_f32_16x16x32_bf16 v[24:27], v[96:99], a[60:63], v[24:27]
v_mfma_f32_16x16x32_bf16 v[48:51], v[96:99], a[124:127], v[48:51]
s_barrier
v_lshlrev_b32 v114, 4, v0
s_mul_i32 s60, s8, 49152
s_lshl_b32 s61, s7, 11
s_add_u32 s60, s60, s61
s_add_u32 s60, s60, 65536
v_add_u32 v115, s60, v114
ds_write_b128 v115, v[4:7] offset:0
ds_write_b128 v115, v[8:11] offset:1024
ds_write_b128 v115, v[12:15] offset:8192
ds_write_b128 v115, v[16:19] offset:9216
ds_write_b128 v115, v[20:23] offset:16384
ds_write_b128 v115, v[24:27] offset:17408
ds_write_b128 v115, v[28:31] offset:24576
ds_write_b128 v115, v[32:35] offset:25600
ds_write_b128 v115, v[36:39] offset:32768
ds_write_b128 v115, v[40:43] offset:33792
ds_write_b128 v115, v[44:47] offset:40960
ds_write_b128 v115, v[48:51] offset:41984
s_mov_b32 s76, 0xbdd2d3e8
s_mov_b32 s77, 0xbdd2d3e8
s_mov_b32 s78, 1.0
s_mov_b32 s79, 1.0
v_mov_b32 v98, 0xc0135761
v_mov_b32 v99, 0xc0135761
s_waitcnt vmcnt(0)
v_lshlrev_b32 v60, 16, v121
v_lshlrev_b32 v61, 16, v121
v_sub_f32 v62, 1.0, v120
v_sub_f32 v63, 1.0, v120
v_lshlrev_b32 v52, 16, v116
v_and_b32 v53, 0xffff0000, v116
v_lshlrev_b32 v54, 16, v117
v_and_b32 v55, 0xffff0000, v117
v_lshlrev_b32 v56, 16, v118
v_and_b32 v57, 0xffff0000, v118
v_lshlrev_b32 v58, 16, v119
v_and_b32 v59, 0xffff0000, v119
v_pk_mul_f32 v[84:85], v[52:53], v[52:53]
v_pk_mul_f32 v[86:87], v[54:55], v[54:55]
v_pk_mul_f32 v[88:89], v[56:57], v[56:57]
v_pk_mul_f32 v[90:91], v[58:59], v[58:59]
v_pk_fma_f32 v[84:85], v[84:85], s[76:77], v[98:99]
v_pk_fma_f32 v[86:87], v[86:87], s[76:77], v[98:99]
v_pk_fma_f32 v[88:89], v[88:89], s[76:77], v[98:99]
v_pk_fma_f32 v[90:91], v[90:91], s[76:77], v[98:99]
v_pk_mul_f32 v[84:85], v[84:85], v[52:53]
v_pk_mul_f32 v[86:87], v[86:87], v[54:55]
v_pk_mul_f32 v[88:89], v[88:89], v[56:57]
v_pk_mul_f32 v[90:91], v[90:91], v[58:59]
v_exp_f32 v84, v84
v_exp_f32 v85, v85
v_exp_f32 v86, v86
v_exp_f32 v87, v87
v_exp_f32 v88, v88
v_exp_f32 v89, v89
v_exp_f32 v90, v90
v_exp_f32 v91, v91
v_pk_add_f32 v[84:85], v[84:85], s[78:79]
v_pk_add_f32 v[86:87], v[86:87], s[78:79]
v_pk_add_f32 v[88:89], v[88:89], s[78:79]
v_pk_add_f32 v[90:91], v[90:91], s[78:79]
v_rcp_f32 v84, v84
v_rcp_f32 v85, v85
v_rcp_f32 v86, v86
v_rcp_f32 v87, v87
v_rcp_f32 v88, v88
v_rcp_f32 v89, v89
v_rcp_f32 v90, v90
v_rcp_f32 v91, v91
v_pk_mul_f32 v[52:53], v[52:53], v[84:85]
v_pk_mul_f32 v[54:55], v[54:55], v[86:87]
v_pk_mul_f32 v[56:57], v[56:57], v[88:89]
v_pk_mul_f32 v[58:59], v[58:59], v[90:91]
v_pk_mul_f32 v[52:53], v[52:53], v[62:63]
v_pk_mul_f32 v[54:55], v[54:55], v[62:63]
v_pk_mul_f32 v[56:57], v[56:57], v[62:63]
v_pk_mul_f32 v[58:59], v[58:59], v[62:63]
s_cmp_ge_u32 s14, 2
s_cbranch_scc1 if_75
v_lshlrev_b32 v76, 16, v113
v_lshlrev_b32 v77, 16, v113
v_sub_f32 v78, 1.0, v112
v_sub_f32 v79, 1.0, v112
v_lshlrev_b32 v68, 16, v122
v_and_b32 v69, 0xffff0000, v122
v_lshlrev_b32 v70, 16, v123
v_and_b32 v71, 0xffff0000, v123
v_lshlrev_b32 v72, 16, v124
v_and_b32 v73, 0xffff0000, v124
v_lshlrev_b32 v74, 16, v125
v_and_b32 v75, 0xffff0000, v125
v_pk_mul_f32 v[84:85], v[68:69], v[68:69]
v_pk_mul_f32 v[86:87], v[70:71], v[70:71]
v_pk_mul_f32 v[88:89], v[72:73], v[72:73]
v_pk_mul_f32 v[90:91], v[74:75], v[74:75]
v_pk_fma_f32 v[84:85], v[84:85], s[76:77], v[98:99]
v_pk_fma_f32 v[86:87], v[86:87], s[76:77], v[98:99]
v_pk_fma_f32 v[88:89], v[88:89], s[76:77], v[98:99]
v_pk_fma_f32 v[90:91], v[90:91], s[76:77], v[98:99]
v_pk_mul_f32 v[84:85], v[84:85], v[68:69]
v_pk_mul_f32 v[86:87], v[86:87], v[70:71]
v_pk_mul_f32 v[88:89], v[88:89], v[72:73]
v_pk_mul_f32 v[90:91], v[90:91], v[74:75]
v_exp_f32 v84, v84
v_exp_f32 v85, v85
v_exp_f32 v86, v86
v_exp_f32 v87, v87
v_exp_f32 v88, v88
v_exp_f32 v89, v89
v_exp_f32 v90, v90
v_exp_f32 v91, v91
v_pk_add_f32 v[84:85], v[84:85], s[78:79]
v_pk_add_f32 v[86:87], v[86:87], s[78:79]
v_pk_add_f32 v[88:89], v[88:89], s[78:79]
v_pk_add_f32 v[90:91], v[90:91], s[78:79]
v_rcp_f32 v84, v84
v_rcp_f32 v85, v85
v_rcp_f32 v86, v86
v_rcp_f32 v87, v87
v_rcp_f32 v88, v88
v_rcp_f32 v89, v89
v_rcp_f32 v90, v90
v_rcp_f32 v91, v91
v_pk_mul_f32 v[68:69], v[68:69], v[84:85]
v_pk_mul_f32 v[70:71], v[70:71], v[86:87]
v_pk_mul_f32 v[72:73], v[72:73], v[88:89]
v_pk_mul_f32 v[74:75], v[74:75], v[90:91]
v_pk_mul_f32 v[68:69], v[68:69], v[78:79]
v_pk_mul_f32 v[70:71], v[70:71], v[78:79]
v_pk_mul_f32 v[72:73], v[72:73], v[78:79]
v_pk_mul_f32 v[74:75], v[74:75], v[78:79]
if_75:
s_waitcnt vmcnt(0) lgkmcnt(0)
s_barrier
s_add_u32 s60, s14, 0
s_lshl_b32 s60, s60, 13
s_mul_i32 s61, s8, 49152
s_add_u32 s60, s60, s61
s_add_u32 s60, s60, 65536
v_add_u32 v115, s60, v114
ds_read_b128 v[4:7], v115 offset:0
ds_read_b128 v[8:11], v115 offset:2048
ds_read_b128 v[12:15], v115 offset:4096
ds_read_b128 v[16:19], v115 offset:6144
ds_read_b128 v[20:23], v115 offset:1024
ds_read_b128 v[24:27], v115 offset:3072
ds_read_b128 v[28:31], v115 offset:5120
ds_read_b128 v[32:35], v115 offset:7168
s_mul_i32 s60, s72, 21
s_mul_i32 s61, s10, 3
s_add_u32 s60, s60, s61
s_add_u32 s60, s60, s12
s_lshl_b32 s60, s60, 10
s_add_u32 s60, s60, 8388608
s_waitcnt lgkmcnt(0)
v_pk_add_f32 v[4:5], v[4:5], v[8:9]
v_pk_add_f32 v[12:13], v[12:13], v[16:17]
v_pk_add_f32 v[6:7], v[6:7], v[10:11]
v_pk_add_f32 v[14:15], v[14:15], v[18:19]
v_pk_add_f32 v[4:5], v[4:5], v[60:61]
v_pk_add_f32 v[6:7], v[6:7], v[60:61]
v_pk_add_f32 v[4:5], v[4:5], v[12:13]
v_pk_add_f32 v[6:7], v[6:7], v[14:15]
v_pk_mul_f32 v[4:5], v[4:5], v[52:53]
v_pk_mul_f32 v[6:7], v[6:7], v[54:55]
v_cvt_pk_bf16_f32 v36, v4, v5
v_cvt_pk_bf16_f32 v37, v6, v7
v_pk_add_f32 v[20:21], v[20:21], v[24:25]
v_pk_add_f32 v[28:29], v[28:29], v[32:33]
v_pk_add_f32 v[22:23], v[22:23], v[26:27]
v_pk_add_f32 v[30:31], v[30:31], v[34:35]
v_pk_add_f32 v[20:21], v[20:21], v[60:61]
v_pk_add_f32 v[22:23], v[22:23], v[60:61]
v_pk_add_f32 v[20:21], v[20:21], v[28:29]
v_pk_add_f32 v[22:23], v[22:23], v[30:31]
v_pk_mul_f32 v[20:21], v[20:21], v[56:57]
v_pk_mul_f32 v[22:23], v[22:23], v[58:59]
v_cvt_pk_bf16_f32 v38, v20, v21
v_cvt_pk_bf16_f32 v39, v22, v23
buffer_store_dwordx4 v[36:39], v114, s[48:51], s60 offen offset:0 sc1
s_cmp_ge_u32 s14, 2
s_cbranch_scc1 if_76
s_add_u32 s60, s14, 4
s_lshl_b32 s60, s60, 13
s_mul_i32 s61, s8, 49152
s_add_u32 s60, s60, s61
s_add_u32 s60, s60, 65536
v_add_u32 v115, s60, v114
ds_read_b128 v[4:7], v115 offset:0
ds_read_b128 v[8:11], v115 offset:2048
ds_read_b128 v[12:15], v115 offset:4096
ds_read_b128 v[16:19], v115 offset:6144
ds_read_b128 v[20:23], v115 offset:1024
ds_read_b128 v[24:27], v115 offset:3072
ds_read_b128 v[28:31], v115 offset:5120
ds_read_b128 v[32:35], v115 offset:7168
s_mul_i32 s60, s73, 21
s_mul_i32 s61, s10, 3
s_add_u32 s60, s60, s61
s_add_u32 s60, s60, s13
s_lshl_b32 s60, s60, 10
s_add_u32 s60, s60, 8388608
s_waitcnt lgkmcnt(0)
v_pk_add_f32 v[4:5], v[4:5], v[8:9]
v_pk_add_f32 v[12:13], v[12:13], v[16:17]
v_pk_add_f32 v[6:7], v[6:7], v[10:11]
v_pk_add_f32 v[14:15], v[14:15], v[18:19]
v_pk_add_f32 v[4:5], v[4:5], v[76:77]
v_pk_add_f32 v[6:7], v[6:7], v[76:77]
v_pk_add_f32 v[4:5], v[4:5], v[12:13]
v_pk_add_f32 v[6:7], v[6:7], v[14:15]
v_pk_mul_f32 v[4:5], v[4:5], v[68:69]
v_pk_mul_f32 v[6:7], v[6:7], v[70:71]
v_cvt_pk_bf16_f32 v40, v4, v5
v_cvt_pk_bf16_f32 v41, v6, v7
v_pk_add_f32 v[20:21], v[20:21], v[24:25]
v_pk_add_f32 v[28:29], v[28:29], v[32:33]
v_pk_add_f32 v[22:23], v[22:23], v[26:27]
v_pk_add_f32 v[30:31], v[30:31], v[34:35]
v_pk_add_f32 v[20:21], v[20:21], v[76:77]
v_pk_add_f32 v[22:23], v[22:23], v[76:77]
v_pk_add_f32 v[20:21], v[20:21], v[28:29]
v_pk_add_f32 v[22:23], v[22:23], v[30:31]
v_pk_mul_f32 v[20:21], v[20:21], v[72:73]
v_pk_mul_f32 v[22:23], v[22:23], v[74:75]
v_cvt_pk_bf16_f32 v42, v20, v21
v_cvt_pk_bf16_f32 v43, v22, v23
buffer_store_dwordx4 v[40:43], v114, s[48:51], s60 offen offset:0 sc1
if_76:
s_lshl_b32 s67, s9, 8
s_add_u32 s67, s67, 15736832
s_mov_b32 s9, s97
s_mov_b32 s10, s98
v_lshlrev_b32 v112, 4, v0
v_lshlrev_b32 v113, 3, v0
s_lshl_b32 s11, s9, 2
s_add_u32 s11, s11, s7
s_lshl_b32 s70, s11, 14
s_add_u32 s70, s70, 12058624
s_lshl_b32 s60, s8, 13
s_add_u32 s70, s70, s60
s_mul_i32 s71, s11, 21504
s_add_u32 s71, s71, 8388608
s_lshl_b32 s72, s11, 9
s_add_u32 s72, s72, 11534336
s_cmp_lg_u32 s6, 0
s_cbranch_scc1 if_77
v_readfirstlane_b32 s64, v105
s_nop 3
s_cmp_ge_u32 s64, 16
s_cbranch_scc1 of_78
s_lshr_b32 s61, s9, 4
s_lshl_b32 s61, s61, 2
s_and_b32 s62, s9, 3
s_add_u32 s61, s61, s62
s_lshl_b32 s61, s61, 8
s_add_u32 s61, s61, 15745024
s_mov_b64 s[68:69], exec
v_mov_b32 v123, 0
v_mov_b32 v124, 0
v_writelane_b32 v123, s61, 0
s_movk_i32 s64, 16
v_writelane_b32 v124, s64, 0
s_mov_b64 exec, 1
s_mov_b32 s65, 0
po_79:
buffer_load_dword v122, v123, s[48:51], 0 offen sc1
s_waitcnt vmcnt(0)
v_cmp_lt_u32 vcc, v122, v124
s_add_u32 s65, s65, 1
s_cmp_lt_u32 s65, 100000
s_cbranch_scc0 pook_80
s_nop 1
s_cbranch_vccz pook_80
s_sleep 1
s_branch po_79
pook_80:
s_mov_b64 exec, s[68:69]
of_78:
if_77:
s_barrier
v_and_b32 v122, 15, v0
v_lshlrev_b32 v122, 2, v122
s_lshl_b32 s60, s11, 6
s_add_u32 s60, s60, 15335424
buffer_load_dword v124, v122, s[48:51], s60 offen sc1
s_add_u32 s63, s70, 4096
buffer_load_dwordx4 v[4:7], v112, s[48:51], s70 offen offset:0 sc1
buffer_load_dwordx4 v[8:11], v112, s[48:51], s70 offen offset:1024 sc1
s_waitcnt vmcnt(3)
s_barrier
s_cmp_lg_u32 s6, 0
s_cbranch_scc1 if_81
s_mov_b64 s[68:69], exec
s_mov_b64 exec, 1
v_mov_b32 v118, 1
v_mov_b32 v119, 0
buffer_atomic_add v118, v119, s[48:51], s67 offen sc1
s_mov_b64 exec, s[68:69]
if_81:
buffer_load_dwordx4 v[12:15], v112, s[48:51], s70 offen offset:2048 sc1
buffer_load_dwordx4 v[16:19], v112, s[48:51], s70 offen offset:3072 sc1
buffer_load_dwordx4 v[20:23], v112, s[48:51], s63 offen offset:0 sc1
buffer_load_dwordx4 v[24:27], v112, s[48:51], s63 offen offset:1024 sc1
buffer_load_dwordx4 v[28:31], v112, s[48:51], s63 offen offset:2048 sc1
buffer_load_dwordx4 v[32:35], v112, s[48:51], s63 offen offset:3072 sc1
s_branch p2end_68
p2left_67:
s_cmp_lg_u32 s8, 0
s_cbranch_scc1 if_82
s_add_u32 m0, s70, 0
s_add_u32 s99, s100, 0
s_and_b32 s99, s99, 0x3fff
buffer_load_dwordx4 v108, s[48:51], s99 offen offset:0 sc1 lds
if_82:
s_cmp_lg_u32 s8, 0
s_cbranch_scc1 if_83
s_add_u32 m0, s70, 24576
s_add_u32 s99, s100, 1024
s_and_b32 s99, s99, 0x3fff
buffer_load_dwordx4 v108, s[48:51], s99 offen offset:0 sc1 lds
if_83:
s_cmp_lg_u32 s8, 0
s_cbranch_scc1 if_84
s_add_u32 m0, s70, 49152
s_add_u32 s99, s100, 2048
s_and_b32 s99, s99, 0x3fff
buffer_load_dwordx4 v108, s[48:51], s99 offen offset:0 sc1 lds
if_84:
s_cmp_lg_u32 s8, 0
s_cbranch_scc1 if_85
s_add_u32 m0, s70, 73728
s_add_u32 s99, s100, 3072
s_and_b32 s99, s99, 0x3fff
buffer_load_dwordx4 v108, s[48:51], s99 offen offset:0 sc1 lds
if_85:
s_waitcnt vmcnt(3)
s_barrier
ds_read_b128 v[52:55], v111 offset:0
s_cmp_lg_u32 s8, 0
s_cbranch_scc1 if_86
s_add_u32 m0, s70, 98304
s_add_u32 s99, s100, 4096
s_and_b32 s99, s99, 0x3fff
buffer_load_dwordx4 v108, s[48:51], s99 offen offset:0 sc1 lds
if_86:
s_waitcnt lgkmcnt(0)
s_waitcnt vmcnt(3)
s_barrier
v_mfma_f32_16x16x32_bf16 v[4:7], v[52:55], a[0:3], 0
ds_read_b128 v[76:79], v111 offset:24576
v_mfma_f32_16x16x32_bf16 v[28:31], v[52:55], a[64:67], 0
s_cmp_lg_u32 s8, 0
s_cbranch_scc1 if_87
s_add_u32 m0, s70, 122880
s_add_u32 s99, s100, 5120
s_and_b32 s99, s99, 0x3fff
buffer_load_dwordx4 v108, s[48:51], s99 offen offset:0 sc1 lds
if_87:
s_waitcnt lgkmcnt(0)
s_waitcnt vmcnt(3)
s_barrier
s_cmp_eq_u32 s8, 0
s_cbranch_scc1 oh_88
s_waitcnt vmcnt(0)
s_branch oh_89
oh_88:
s_waitcnt vmcnt(6)
oh_89:
v_mfma_f32_16x16x32_bf16 v[4:7], v[76:79], a[4:7], v[4:7]
ds_read_b128 v[52:55], v111 offset:49152
v_mfma_f32_16x16x32_bf16 v[28:31], v[76:79], a[68:71], v[28:31]
s_cmp_lg_u32 s8, 0
s_cbranch_scc1 if_90
s_add_u32 m0, s70, 0
s_add_u32 s99, s100, 6144
s_and_b32 s99, s99, 0x3fff
buffer_load_dwordx4 v108, s[48:51], s99 offen offset:0 sc1 lds
if_90:
s_waitcnt lgkmcnt(0)
s_waitcnt vmcnt(3)
s_barrier
v_add_u32 v114, 73728, v111
s_cmp_lg_u32 s6, 0
s_cbranch_scc1 if_91
s_and_b32 s60, s9, 1
s_lshl_b32 s60, s60, 10
s_add_u32 s60, s60, 15745024
s_mov_b64 s[68:69], exec
s_mov_b64 exec, 15
v_mov_b32 v116, 1
v_mul_u32_u24 v117, 256, v0
buffer_atomic_add v116, v117, s[48:51], s60 offen sc1
s_mov_b64 exec, s[68:69]
if_91:
v_mfma_f32_16x16x32_bf16 v[4:7], v[52:55], a[8:11], v[4:7]
ds_read_b128 v[76:79], v114 offset:0
v_mfma_f32_16x16x32_bf16 v[28:31], v[52:55], a[72:75], v[28:31]
s_cmp_lg_u32 s8, 0
s_cbranch_scc1 if_92
s_add_u32 m0, s70, 24576
s_add_u32 s99, s100, 7168
s_and_b32 s99, s99, 0x3fff
buffer_load_dwordx4 v108, s[48:51], s99 offen offset:0 sc1 lds
if_92:
s_waitcnt lgkmcnt(0)
s_waitcnt vmcnt(3)
s_barrier
v_add_u32 v114, 98304, v111
v_mfma_f32_16x16x32_bf16 v[4:7], v[76:79], a[12:15], v[4:7]
ds_read_b128 v[52:55], v114 offset:0
v_mfma_f32_16x16x32_bf16 v[28:31], v[76:79], a[76:79], v[28:31]
s_cmp_lg_u32 s8, 0
s_cbranch_scc1 if_93
s_add_u32 m0, s70, 49152
s_add_u32 s99, s100, 8192
s_and_b32 s99, s99, 0x3fff
buffer_load_dwordx4 v108, s[48:51], s99 offen offset:0 sc1 lds
if_93:
s_waitcnt lgkmcnt(0)
s_waitcnt vmcnt(3)
s_barrier
v_add_u32 v114, 122880, v111
s_cmp_lg_u32 s6, 0
s_cbranch_scc1 if_94
s_lshl_b32 s60, s10, 8
s_add_u32 s60, s60, 15747072
s_add_u32 s61, s10, 1
s_and_b32 s61, s61, 7
s_lshl_b32 s61, s61, 8
s_add_u32 s61, s61, 15747072
v_mov_b32 v113, 15748864
v_writelane_b32 v113, s60, 0
v_writelane_b32 v113, s61, 1
buffer_load_dword v105, v113, s[48:51], 0 offen sc1
if_94:
v_mfma_f32_16x16x32_bf16 v[4:7], v[52:55], a[16:19], v[4:7]
ds_read_b128 v[76:79], v114 offset:0
v_mfma_f32_16x16x32_bf16 v[28:31], v[52:55], a[80:83], v[28:31]
s_cmp_lg_u32 s8, 0
s_cbranch_scc1 if_95
s_add_u32 m0, s70, 73728
s_add_u32 s99, s100, 9216
s_and_b32 s99, s99, 0x3fff
buffer_load_dwordx4 v108, s[48:51], s99 offen offset:0 sc1 lds
if_95:
s_waitcnt lgkmcnt(0)
s_waitcnt vmcnt(3)
s_barrier
v_mfma_f32_16x16x32_bf16 v[4:7], v[76:79], a[20:23], v[4:7]
ds_read_b128 v[52:55], v111 offset:0
v_mfma_f32_16x16x32_bf16 v[28:31], v[76:79], a[84:87], v[28:31]
s_cmp_lg_u32 s8, 0
s_cbranch_scc1 if_96
s_add_u32 m0, s70, 98304
s_add_u32 s99, s100, 10240
s_and_b32 s99, s99, 0x3fff
buffer_load_dwordx4 v108, s[48:51], s99 offen offset:0 sc1 lds
if_96:
s_waitcnt lgkmcnt(0)
s_waitcnt vmcnt(3)
s_barrier
v_mfma_f32_16x16x32_bf16 v[4:7], v[52:55], a[24:27], v[4:7]
ds_read_b128 v[76:79], v111 offset:24576
v_mfma_f32_16x16x32_bf16 v[28:31], v[52:55], a[88:91], v[28:31]
s_cmp_lg_u32 s8, 0
s_cbranch_scc1 if_97
s_add_u32 m0, s70, 122880
s_add_u32 s99, s100, 11264
s_and_b32 s99, s99, 0x3fff
buffer_load_dwordx4 v108, s[48:51], s99 offen offset:0 sc1 lds
if_97:
s_waitcnt lgkmcnt(0)
s_waitcnt vmcnt(3)
s_barrier
v_mfma_f32_16x16x32_bf16 v[4:7], v[76:79], a[28:31], v[4:7]
ds_read_b128 v[52:55], v111 offset:49152
v_mfma_f32_16x16x32_bf16 v[28:31], v[76:79], a[92:95], v[28:31]
s_cmp_lg_u32 s8, 0
s_cbranch_scc1 if_98
s_add_u32 m0, s70, 0
s_add_u32 s99, s100, 12288
s_and_b32 s99, s99, 0x3fff
buffer_load_dwordx4 v108, s[48:51], s99 offen offset:0 sc1 lds
if_98:
s_waitcnt lgkmcnt(0)
s_waitcnt vmcnt(3)
s_barrier
v_add_u32 v114, 73728, v111
v_mfma_f32_16x16x32_bf16 v[4:7], v[52:55], a[32:35], v[4:7]
ds_read_b128 v[76:79], v114 offset:0
v_mfma_f32_16x16x32_bf16 v[28:31], v[52:55], a[96:99], v[28:31]
s_cmp_lg_u32 s8, 0
s_cbranch_scc1 if_99
s_add_u32 m0, s70, 24576
s_add_u32 s99, s100, 13312
s_and_b32 s99, s99, 0x3fff
buffer_load_dwordx4 v108, s[48:51], s99 offen offset:0 sc1 lds
if_99:
s_waitcnt lgkmcnt(0)
s_waitcnt vmcnt(3)
s_barrier
v_add_u32 v114, 98304, v111
s_cmp_lg_u32 s6, 0
s_cbranch_scc1 if_100
v_cmp_gt_u32 vcc, 16, v105
s_nop 4
s_cbranch_vccz zd_101
s_lshl_b32 s60, s10, 8
s_add_u32 s60, s60, 15747072
s_add_u32 s61, s10, 1
s_and_b32 s61, s61, 7
s_lshl_b32 s61, s61, 8
s_add_u32 s61, s61, 15747072
s_mov_b32 s62, 15748864
s_mov_b64 s[68:69], exec
v_mov_b32 v117, 0
v_mov_b32 v118, 0
v_writelane_b32 v117, s60, 0
s_movk_i32 s64, 16
v_writelane_b32 v118, s64, 0
v_writelane_b32 v117, s61, 1
s_movk_i32 s64, 16
v_writelane_b32 v118, s64, 1
v_writelane_b32 v117, s62, 2
s_movk_i32 s64, 16
v_writelane_b32 v118, s64, 2
s_mov_b64 exec, 7
s_mov_b32 s65, 0
pz1_102:
buffer_load_dword v116, v117, s[48:51], 0 offen sc1
s_waitcnt vmcnt(0)
v_cmp_lt_u32 vcc, v116, v118
s_add_u32 s65, s65, 1
s_cmp_lt_u32 s65, 100000
s_cbranch_scc0 pz1ok_103
s_nop 1
s_cbranch_vccz pz1ok_103
s_sleep 1
s_branch pz1_102
pz1ok_103:
s_mov_b64 exec, s[68:69]
zd_101:
if_100:
v_mfma_f32_16x16x32_bf16 v[4:7], v[76:79], a[36:39], v[4:7]
ds_read_b128 v[52:55], v114 offset:0
v_mfma_f32_16x16x32_bf16 v[28:31], v[76:79], a[100:103], v[28:31]
s_cmp_lg_u32 s8, 0
s_cbranch_scc1 if_104
s_add_u32 m0, s70, 49152
s_add_u32 s99, s100, 14336
s_and_b32 s99, s99, 0x3fff
buffer_load_dwordx4 v108, s[48:51], s99 offen offset:0 sc1 lds
if_104:
s_waitcnt lgkmcnt(0)
s_waitcnt vmcnt(3)
s_barrier
v_add_u32 v114, 122880, v111
v_mfma_f32_16x16x32_bf16 v[4:7], v[52:55], a[40:43], v[4:7]
ds_read_b128 v[76:79], v114 offset:0
s_cmp_lg_u32 s8, 0
s_cbranch_scc1 if_105
s_add_u32 m0, s70, 73728
s_add_u32 s99, s100, 15360
s_and_b32 s99, s99, 0x3fff
buffer_load_dwordx4 v108, s[48:51], s99 offen offset:0 sc1 lds
if_105:
v_mfma_f32_16x16x32_bf16 v[28:31], v[52:55], a[104:107], v[28:31]
s_and_b32 s61, s14, 1
s_mov_b32 s12, 0
s_lshl_b32 s63, s9, 2
s_lshl_b32 s64, s8, 1
s_add_u32 s63, s63, s64
s_add_u32 s72, s63, s61
s_lshr_b32 s63, s72, 1
s_mul_i32 s64, s63, 43
s_add_u32 s64, s64, s11
s_lshl_b32 s62, s12, 1
s_add_u32 s64, s64, s62
s_lshl_b32 s64, s64, 10
s_add_u32 s64, s64, 3145728
s_and_b32 s63, s72, 1
s_lshl_b32 s63, s63, 3
s_add_u32 s64, s64, s63
v_lshlrev_b32 v115, 4, v0
buffer_load_dwordx2 v[116:117], v115, s[48:51], s64 offen sc1
buffer_load_dwordx2 v[118:119], v115, s[48:51], s64 offen offset:0 sc1
v_and_b32 v126, 15, v0
v_lshlrev_b32 v115, 2, v126
s_lshl_b32 s64, s72, 6
s_add_u32 s64, s64, 15335424
buffer_load_dword v120, v115, s[48:51], s64 offen sc1
v_lshlrev_b32 v126, 1, v126
s_lshl_b32 s64, s72, 5
buffer_load_ushort v121, v126, s[56:59], s64 offen
s_waitcnt lgkmcnt(0)
s_waitcnt vmcnt(7)
s_barrier
v_mfma_f32_16x16x32_bf16 v[4:7], v[76:79], a[44:47], v[4:7]
ds_read_b128 v[52:55], v111 offset:0
v_mfma_f32_16x16x32_bf16 v[28:31], v[76:79], a[108:111], v[28:31]
s_waitcnt lgkmcnt(0)
s_waitcnt vmcnt(6)
s_barrier
v_mfma_f32_16x16x32_bf16 v[4:7], v[52:55], a[48:51], v[4:7]
ds_read_b128 v[76:79], v111 offset:24576
s_add_u32 m0, s75, 0
s_mov_b32 s66, 0
buffer_load_dwordx4 v104, s[40:43], s66 offen  lds
s_add_u32 m0, s75, 8192
s_mov_b32 s66, 65536
buffer_load_dwordx4 v104, s[40:43], s66 offen  lds
v_mfma_f32_16x16x32_bf16 v[28:31], v[52:55], a[112:115], v[28:31]
s_add_u32 m0, s75, 16384
s_mov_b32 s66, 131072
buffer_load_dwordx4 v104, s[40:43], s66 offen  lds
s_waitcnt lgkmcnt(0)
s_waitcnt vmcnt(8)
s_barrier
v_mfma_f32_16x16x32_bf16 v[4:7], v[76:79], a[52:55], v[4:7]
ds_read_b128 v[52:55], v111 offset:49152
s_add_u32 m0, s75, 24576
s_mov_b32 s66, 196608
buffer_load_dwordx4 v104, s[40:43], s66 offen  lds
s_add_u32 m0, s75, 32768
s_mov_b32 s66, 262144
buffer_load_dwordx4 v104, s[40:43], s66 offen  lds
v_mfma_f32_16x16x32_bf16 v[28:31], v[76:79], a[116:119], v[28:31]
s_add_u32 m0, s75, 40960
s_mov_b32 s66, 327680
buffer_load_dwordx4 v104, s[40:43], s66 offen  lds
s_waitcnt lgkmcnt(0)
s_waitcnt vmcnt(10)
s_barrier
v_add_u32 v114, 73728, v111
s_cmp_lg_u32 s6, 0
s_cbranch_scc1 if_106
s_lshr_b32 s61, s97, 4
s_lshl_b32 s61, s61, 2
s_and_b32 s62, s97, 3
s_add_u32 s61, s61, s62
s_lshl_b32 s61, s61, 8
s_add_u32 s61, s61, 15745024
v_mov_b32 v1, 0
buffer_load_dword v105, v1, s[48:51], s61 offen sc1
if_106:
v_mfma_f32_16x16x32_bf16 v[4:7], v[52:55], a[56:59], v[4:7]
ds_read_b128 v[76:79], v114 offset:0
s_add_u32 m0, s75, 49152
s_mov_b32 s66, 393216
buffer_load_dwordx4 v104, s[40:43], s66 offen  lds
v_mfma_f32_16x16x32_bf16 v[28:31], v[52:55], a[120:123], v[28:31]
s_add_u32 m0, s75, 57344
s_mov_b32 s66, 458752
buffer_load_dwordx4 v104, s[40:43], s66 offen  lds
s_waitcnt lgkmcnt(0)
v_mfma_f32_16x16x32_bf16 v[4:7], v[76:79], a[60:63], v[4:7]
v_mfma_f32_16x16x32_bf16 v[28:31], v[76:79], a[124:127], v[28:31]
s_barrier
v_lshlrev_b32 v114, 4, v0
s_mul_i32 s60, s8, 49152
s_lshl_b32 s61, s7, 11
s_add_u32 s60, s60, s61
s_add_u32 s60, s60, 65536
v_add_u32 v115, s60, v114
ds_write_b128 v115, v[4:7] offset:0
ds_write_b128 v115, v[28:31] offset:8192
s_mov_b32 s76, 0xbdd2d3e8
s_mov_b32 s77, 0xbdd2d3e8
s_mov_b32 s78, 1.0
s_mov_b32 s79, 1.0
v_mov_b32 v98, 0xc0135761
v_mov_b32 v99, 0xc0135761
s_waitcnt vmcnt(0)
s_cmp_ge_u32 s14, 2
s_cbranch_scc1 if_107
v_lshlrev_b32 v60, 16, v121
v_lshlrev_b32 v61, 16, v121
v_sub_f32 v62, 1.0, v120
v_sub_f32 v63, 1.0, v120
v_lshlrev_b32 v52, 16, v116
v_and_b32 v53, 0xffff0000, v116
v_lshlrev_b32 v54, 16, v117
v_and_b32 v55, 0xffff0000, v117
v_pk_mul_f32 v[84:85], v[52:53], v[52:53]
v_pk_mul_f32 v[86:87], v[54:55], v[54:55]
v_pk_fma_f32 v[84:85], v[84:85], s[76:77], v[98:99]
v_pk_fma_f32 v[86:87], v[86:87], s[76:77], v[98:99]
v_pk_mul_f32 v[84:85], v[84:85], v[52:53]
v_pk_mul_f32 v[86:87], v[86:87], v[54:55]
v_exp_f32 v84, v84
v_exp_f32 v85, v85
v_exp_f32 v86, v86
v_exp_f32 v87, v87
v_pk_add_f32 v[84:85], v[84:85], s[78:79]
v_pk_add_f32 v[86:87], v[86:87], s[78:79]
v_rcp_f32 v84, v84
v_rcp_f32 v85, v85
v_rcp_f32 v86, v86
v_rcp_f32 v87, v87
v_pk_mul_f32 v[52:53], v[52:53], v[84:85]
v_pk_mul_f32 v[54:55], v[54:55], v[86:87]
v_pk_mul_f32 v[52:53], v[52:53], v[62:63]
v_pk_mul_f32 v[54:55], v[54:55], v[62:63]
if_107:
s_waitcnt vmcnt(0) lgkmcnt(0)
s_barrier
s_cmp_ge_u32 s14, 2
s_cbranch_scc1 if_108
s_add_u32 s60, s14, 0
s_lshl_b32 s60, s60, 13
s_mul_i32 s61, s8, 49152
s_add_u32 s60, s60, s61
s_add_u32 s60, s60, 65536
v_add_u32 v115, s60, v114
ds_read_b128 v[4:7], v115 offset:0
ds_read_b128 v[8:11], v115 offset:2048
ds_read_b128 v[12:15], v115 offset:4096
ds_read_b128 v[16:19], v115 offset:6144
s_lshl_b32 s60, s72, 9
s_add_u32 s60, s60, 11534336
s_waitcnt lgkmcnt(0)
v_pk_add_f32 v[4:5], v[4:5], v[8:9]
v_pk_add_f32 v[12:13], v[12:13], v[16:17]
v_pk_add_f32 v[6:7], v[6:7], v[10:11]
v_pk_add_f32 v[14:15], v[14:15], v[18:19]
v_pk_add_f32 v[4:5], v[4:5], v[60:61]
v_pk_add_f32 v[6:7], v[6:7], v[60:61]
v_pk_add_f32 v[4:5], v[4:5], v[12:13]
v_pk_add_f32 v[6:7], v[6:7], v[14:15]
v_pk_mul_f32 v[4:5], v[4:5], v[52:53]
v_pk_mul_f32 v[6:7], v[6:7], v[54:55]
v_cvt_pk_bf16_f32 v36, v4, v5
v_cvt_pk_bf16_f32 v37, v6, v7
v_lshlrev_b32 v115, 3, v0
buffer_store_dwordx2 v[36:37], v115, s[48:51], s60 offen offset:0 sc1
if_108:
s_lshl_b32 s67, s9, 8
s_add_u32 s67, s67, 15736832
s_mov_b32 s9, s97
s_mov_b32 s10, s98
v_lshlrev_b32 v112, 4, v0
v_lshlrev_b32 v113, 3, v0
s_lshl_b32 s11, s9, 2
s_add_u32 s11, s11, s7
s_lshl_b32 s70, s11, 14
s_add_u32 s70, s70, 12058624
s_lshl_b32 s60, s8, 13
s_add_u32 s70, s70, s60
s_mul_i32 s71, s11, 21504
s_add_u32 s71, s71, 8388608
s_lshl_b32 s72, s11, 9
s_add_u32 s72, s72, 11534336
s_cmp_lg_u32 s6, 0
s_cbranch_scc1 if_109
v_readfirstlane_b32 s64, v105
s_nop 3
s_cmp_ge_u32 s64, 16
s_cbranch_scc1 of_110
s_lshr_b32 s61, s9, 4
s_lshl_b32 s61, s61, 2
s_and_b32 s62, s9, 3
s_add_u32 s61, s61, s62
s_lshl_b32 s61, s61, 8
s_add_u32 s61, s61, 15745024
s_mov_b64 s[68:69], exec
v_mov_b32 v123, 0
v_mov_b32 v124, 0
v_writelane_b32 v123, s61, 0
s_movk_i32 s64, 16
v_writelane_b32 v124, s64, 0
s_mov_b64 exec, 1
s_mov_b32 s65, 0
po_111:
buffer_load_dword v122, v123, s[48:51], 0 offen sc1
s_waitcnt vmcnt(0)
v_cmp_lt_u32 vcc, v122, v124
s_add_u32 s65, s65, 1
s_cmp_lt_u32 s65, 100000
s_cbranch_scc0 pook_112
s_nop 1
s_cbranch_vccz pook_112
s_sleep 1
s_branch po_111
pook_112:
s_mov_b64 exec, s[68:69]
of_110:
if_109:
s_barrier
v_and_b32 v122, 15, v0
v_lshlrev_b32 v122, 2, v122
s_lshl_b32 s60, s11, 6
s_add_u32 s60, s60, 15335424
buffer_load_dword v124, v122, s[48:51], s60 offen sc1
s_add_u32 s63, s70, 4096
buffer_load_dwordx4 v[4:7], v112, s[48:51], s70 offen offset:0 sc1
buffer_load_dwordx4 v[8:11], v112, s[48:51], s70 offen offset:1024 sc1
s_waitcnt vmcnt(3)
s_barrier
s_cmp_lg_u32 s6, 0
s_cbranch_scc1 if_113
s_mov_b64 s[68:69], exec
s_mov_b64 exec, 1
v_mov_b32 v118, 1
v_mov_b32 v119, 0
buffer_atomic_add v118, v119, s[48:51], s67 offen sc1
s_mov_b64 exec, s[68:69]
if_113:
buffer_load_dwordx4 v[12:15], v112, s[48:51], s70 offen offset:2048 sc1
buffer_load_dwordx4 v[16:19], v112, s[48:51], s70 offen offset:3072 sc1
buffer_load_dwordx4 v[20:23], v112, s[48:51], s63 offen offset:0 sc1
buffer_load_dwordx4 v[24:27], v112, s[48:51], s63 offen offset:1024 sc1
buffer_load_dwordx4 v[28:31], v112, s[48:51], s63 offen offset:2048 sc1
buffer_load_dwordx4 v[32:35], v112, s[48:51], s63 offen offset:3072 sc1
p2end_68:
s_lshl_b32 s60, s8, 15
v_add_u32 v114, s60, v100
v_add_u32 v115, s60, v101
v_add_u32 v116, s60, v102
v_add_u32 v117, s60, v103
ds_read_b64_tr_b16 a[0:1], v114 offset:0
ds_read_b64_tr_b16 a[2:3], v114 offset:2048
ds_read_b64_tr_b16 a[4:5], v115 offset:0
ds_read_b64_tr_b16 a[6:7], v115 offset:2048
ds_read_b64_tr_b16 a[8:9], v116 offset:0
ds_read_b64_tr_b16 a[10:11], v116 offset:2048
ds_read_b64_tr_b16 a[12:13], v117 offset:0
ds_read_b64_tr_b16 a[14:15], v117 offset:2048
s_add_u32 m0, s75, 65536
s_mov_b32 s66, 0
buffer_load_dwordx4 v104, s[44:47], s66 offen  lds
s_add_u32 m0, s75, 73728
s_mov_b32 s66, 65536
buffer_load_dwordx4 v104, s[44:47], s66 offen  lds
s_waitcnt vmcnt(9) lgkmcnt(0)
v_mfma_f32_16x16x32_bf16 v[80:83], a[0:3], v[4:7], 0
ds_read_b64_tr_b16 a[16:17], v114 offset:4096
ds_read_b64_tr_b16 a[18:19], v114 offset:6144
v_mfma_f32_16x16x32_bf16 v[84:87], a[4:7], v[4:7], 0
ds_read_b64_tr_b16 a[20:21], v115 offset:4096
ds_read_b64_tr_b16 a[22:23], v115 offset:6144
s_add_u32 m0, s75, 81920
s_mov_b32 s66, 131072
buffer_load_dwordx4 v104, s[44:47], s66 offen  lds
v_mfma_f32_16x16x32_bf16 v[88:91], a[8:11], v[4:7], 0
ds_read_b64_tr_b16 a[24:25], v116 offset:4096
ds_read_b64_tr_b16 a[26:27], v116 offset:6144
v_mfma_f32_16x16x32_bf16 v[92:95], a[12:15], v[4:7], 0
ds_read_b64_tr_b16 a[28:29], v117 offset:4096
ds_read_b64_tr_b16 a[30:31], v117 offset:6144
s_add_u32 m0, s75, 90112
s_mov_b32 s66, 196608
buffer_load_dwordx4 v104, s[44:47], s66 offen  lds
s_waitcnt vmcnt(10) lgkmcnt(0)
v_mfma_f32_16x16x32_bf16 v[80:83], a[16:19], v[8:11], v[80:83]
ds_read_b64_tr_b16 a[0:1], v114 offset:8192
ds_read_b64_tr_b16 a[2:3], v114 offset:10240
v_mfma_f32_16x16x32_bf16 v[84:87], a[20:23], v[8:11], v[84:87]
ds_read_b64_tr_b16 a[4:5], v115 offset:8192
ds_read_b64_tr_b16 a[6:7], v115 offset:10240
s_add_u32 m0, s75, 98304
s_mov_b32 s66, 262144
buffer_load_dwordx4 v104, s[44:47], s66 offen  lds
v_mfma_f32_16x16x32_bf16 v[88:91], a[24:27], v[8:11], v[88:91]
ds_read_b64_tr_b16 a[8:9], v116 offset:8192
ds_read_b64_tr_b16 a[10:11], v116 offset:10240
v_mfma_f32_16x16x32_bf16 v[92:95], a[28:31], v[8:11], v[92:95]
ds_read_b64_tr_b16 a[12:13], v117 offset:8192
ds_read_b64_tr_b16 a[14:15], v117 offset:10240
s_add_u32 m0, s75, 106496
s_mov_b32 s66, 327680
buffer_load_dwordx4 v104, s[44:47], s66 offen  lds
s_waitcnt vmcnt(11) lgkmcnt(0)
v_mfma_f32_16x16x32_bf16 v[80:83], a[0:3], v[12:15], v[80:83]
ds_read_b64_tr_b16 a[16:17], v114 offset:12288
ds_read_b64_tr_b16 a[18:19], v114 offset:14336
v_mfma_f32_16x16x32_bf16 v[84:87], a[4:7], v[12:15], v[84:87]
ds_read_b64_tr_b16 a[20:21], v115 offset:12288
ds_read_b64_tr_b16 a[22:23], v115 offset:14336
s_add_u32 m0, s75, 114688
s_mov_b32 s66, 393216
buffer_load_dwordx4 v104, s[44:47], s66 offen  lds
v_mfma_f32_16x16x32_bf16 v[88:91], a[8:11], v[12:15], v[88:91]
ds_read_b64_tr_b16 a[24:25], v116 offset:12288
ds_read_b64_tr_b16 a[26:27], v116 offset:14336
v_mfma_f32_16x16x32_bf16 v[92:95], a[12:15], v[12:15], v[92:95]
ds_read_b64_tr_b16 a[28:29], v117 offset:12288
ds_read_b64_tr_b16 a[30:31], v117 offset:14336
s_add_u32 m0, s75, 122880
s_mov_b32 s66, 458752
buffer_load_dwordx4 v104, s[44:47], s66 offen  lds
s_waitcnt vmcnt(12) lgkmcnt(0)
v_mfma_f32_16x16x32_bf16 v[80:83], a[16:19], v[16:19], v[80:83]
ds_read_b64_tr_b16 a[0:1], v114 offset:16384
ds_read_b64_tr_b16 a[2:3], v114 offset:18432
v_mfma_f32_16x16x32_bf16 v[84:87], a[20:23], v[16:19], v[84:87]
ds_read_b64_tr_b16 a[4:5], v115 offset:16384
ds_read_b64_tr_b16 a[6:7], v115 offset:18432
v_mfma_f32_16x16x32_bf16 v[88:91], a[24:27], v[16:19], v[88:91]
ds_read_b64_tr_b16 a[8:9], v116 offset:16384
ds_read_b64_tr_b16 a[10:11], v116 offset:18432
s_add_u32 m0, s75, 131072
s_mov_b32 s66, 524288
buffer_load_dwordx4 v104, s[44:47], s66 offen  lds
v_mfma_f32_16x16x32_bf16 v[92:95], a[28:31], v[16:19], v[92:95]
ds_read_b64_tr_b16 a[12:13], v117 offset:16384
ds_read_b64_tr_b16 a[14:15], v117 offset:18432
s_waitcnt vmcnt(12) lgkmcnt(0)
v_mfma_f32_16x16x32_bf16 v[80:83], a[0:3], v[20:23], v[80:83]
ds_read_b64_tr_b16 a[16:17], v114 offset:20480
ds_read_b64_tr_b16 a[18:19], v114 offset:22528
v_mfma_f32_16x16x32_bf16 v[84:87], a[4:7], v[20:23], v[84:87]
ds_read_b64_tr_b16 a[20:21], v115 offset:20480
ds_read_b64_tr_b16 a[22:23], v115 offset:22528
v_mfma_f32_16x16x32_bf16 v[88:91], a[8:11], v[20:23], v[88:91]
ds_read_b64_tr_b16 a[24:25], v116 offset:20480
ds_read_b64_tr_b16 a[26:27], v116 offset:22528
s_add_u32 m0, s75, 139264
s_mov_b32 s66, 589824
buffer_load_dwordx4 v104, s[44:47], s66 offen  lds
v_mfma_f32_16x16x32_bf16 v[92:95], a[12:15], v[20:23], v[92:95]
ds_read_b64_tr_b16 a[28:29], v117 offset:20480
ds_read_b64_tr_b16 a[30:31], v117 offset:22528
s_waitcnt vmcnt(12) lgkmcnt(0)
v_mfma_f32_16x16x32_bf16 v[80:83], a[16:19], v[24:27], v[80:83]
ds_read_b64_tr_b16 a[0:1], v114 offset:24576
ds_read_b64_tr_b16 a[2:3], v114 offset:26624
v_mfma_f32_16x16x32_bf16 v[84:87], a[20:23], v[24:27], v[84:87]
ds_read_b64_tr_b16 a[4:5], v115 offset:24576
ds_read_b64_tr_b16 a[6:7], v115 offset:26624
v_mfma_f32_16x16x32_bf16 v[88:91], a[24:27], v[24:27], v[88:91]
ds_read_b64_tr_b16 a[8:9], v116 offset:24576
ds_read_b64_tr_b16 a[10:11], v116 offset:26624
s_cmp_ge_u32 s6, 6
s_cbranch_scc1 if_114
s_add_u32 m0, s75, 147456
s_mov_b32 s66, 655360
buffer_load_dwordx4 v104, s[44:47], s66 offen  lds
if_114:
v_mfma_f32_16x16x32_bf16 v[92:95], a[28:31], v[24:27], v[92:95]
ds_read_b64_tr_b16 a[12:13], v117 offset:24576
ds_read_b64_tr_b16 a[14:15], v117 offset:26624
s_waitcnt vmcnt(11) lgkmcnt(0)
v_mfma_f32_16x16x32_bf16 v[80:83], a[0:3], v[28:31], v[80:83]
ds_read_b64_tr_b16 a[16:17], v114 offset:28672
ds_read_b64_tr_b16 a[18:19], v114 offset:30720
v_mfma_f32_16x16x32_bf16 v[84:87], a[4:7], v[28:31], v[84:87]
ds_read_b64_tr_b16 a[20:21], v115 offset:28672
ds_read_b64_tr_b16 a[22:23], v115 offset:30720
v_mfma_f32_16x16x32_bf16 v[88:91], a[8:11], v[28:31], v[88:91]
ds_read_b64_tr_b16 a[24:25], v116 offset:28672
ds_read_b64_tr_b16 a[26:27], v116 offset:30720
s_cmp_lg_u32 s6, 0
s_cbranch_scc1 if_115
s_lshl_b32 s60, s9, 8
s_add_u32 s60, s60, 15736832
v_mov_b32 v1, 0
buffer_load_dword v105, v1, s[48:51], s60 offen sc1
if_115:
v_mfma_f32_16x16x32_bf16 v[92:95], a[12:15], v[28:31], v[92:95]
ds_read_b64_tr_b16 a[28:29], v117 offset:28672
ds_read_b64_tr_b16 a[30:31], v117 offset:30720
s_waitcnt vmcnt(10) lgkmcnt(0)
v_mfma_f32_16x16x32_bf16 v[80:83], a[16:19], v[32:35], v[80:83]
v_mfma_f32_16x16x32_bf16 v[84:87], a[20:23], v[32:35], v[84:87]
v_mfma_f32_16x16x32_bf16 v[88:91], a[24:27], v[32:35], v[88:91]
v_mfma_f32_16x16x32_bf16 v[92:95], a[28:31], v[32:35], v[92:95]
v_mov_b32 v125, v124
s_nop 3
v_pk_mul_f32 v[80:81], v[80:81], v[124:125]
v_pk_mul_f32 v[82:83], v[82:83], v[124:125]
v_pk_mul_f32 v[84:85], v[84:85], v[124:125]
v_pk_mul_f32 v[86:87], v[86:87], v[124:125]
v_pk_mul_f32 v[88:89], v[88:89], v[124:125]
v_pk_mul_f32 v[90:91], v[90:91], v[124:125]
v_pk_mul_f32 v[92:93], v[92:93], v[124:125]
v_pk_mul_f32 v[94:95], v[94:95], v[124:125]
s_waitcnt vmcnt(0)
s_cmp_lg_u32 s6, 0
s_cbranch_scc1 if_116
v_readfirstlane_b32 s64, v105
s_nop 3
s_cmp_ge_u32 s64, 8
s_cbranch_scc1 uf_117
s_lshl_b32 s60, s9, 8
s_add_u32 s60, s60, 15736832
s_mov_b64 s[68:69], exec
v_mov_b32 v123, 0
v_mov_b32 v124, 0
v_writelane_b32 v123, s60, 0
s_movk_i32 s64, 8
v_writelane_b32 v124, s64, 0
s_mov_b64 exec, 1
s_mov_b32 s65, 0
pu_118:
buffer_load_dword v122, v123, s[48:51], 0 offen sc1
s_waitcnt vmcnt(0)
v_cmp_lt_u32 vcc, v122, v124
s_add_u32 s65, s65, 1
s_cmp_lt_u32 s65, 100000
s_cbranch_scc0 puok_119
s_nop 1
s_cbranch_vccz puok_119
s_sleep 1
s_branch pu_118
puok_119:
s_mov_b64 exec, s[68:69]
uf_117:
if_116:
s_barrier
s_cmp_lg_u32 s8, 0
s_cbranch_scc1 p3k1_120
s_add_u32 s63, s71, 0
buffer_load_dwordx4 v[36:39], v112, s[48:51], s63 offen sc1
s_add_u32 s63, s71, 1024
buffer_load_dwordx4 v[40:43], v112, s[48:51], s63 offen sc1
s_add_u32 s63, s71, 2048
buffer_load_dwordx4 v[44:47], v112, s[48:51], s63 offen sc1
v_add_u32 v114, 67584, v100
v_add_u32 v115, 67584, v101
v_add_u32 v116, 67584, v102
v_add_u32 v117, 67584, v103
ds_read_b64_tr_b16 a[0:1], v114 offset:0
ds_read_b64_tr_b16 a[2:3], v114 offset:2048
ds_read_b64_tr_b16 a[4:5], v115 offset:0
ds_read_b64_tr_b16 a[6:7], v115 offset:2048
ds_read_b64_tr_b16 a[8:9], v116 offset:0
ds_read_b64_tr_b16 a[10:11], v116 offset:2048
ds_read_b64_tr_b16 a[12:13], v117 offset:0
ds_read_b64_tr_b16 a[14:15], v117 offset:2048
s_add_u32 s63, s71, 3072
buffer_load_dwordx4 v[48:51], v112, s[48:51], s63 offen sc1
s_waitcnt vmcnt(3) lgkmcnt(0)
v_add_u32 v118, 71680, v100
v_add_u32 v119, 71680, v101
v_add_u32 v120, 71680, v102
v_add_u32 v121, 71680, v103
v_mfma_f32_16x16x32_bf16 v[80:83], a[0:3], v[36:39], v[80:83]
ds_read_b64_tr_b16 a[16:17], v118 offset:0
ds_read_b64_tr_b16 a[18:19], v118 offset:2048
v_mfma_f32_16x16x32_bf16 v[84:87], a[4:7], v[36:39], v[84:87]
ds_read_b64_tr_b16 a[20:21], v119 offset:0
ds_read_b64_tr_b16 a[22:23], v119 offset:2048
v_mfma_f32_16x16x32_bf16 v[88:91], a[8:11], v[36:39], v[88:91]
ds_read_b64_tr_b16 a[24:25], v120 offset:0
ds_read_b64_tr_b16 a[26:27], v120 offset:2048
s_add_u32 s63, s71, 4096
buffer_load_dwordx4 v[52:55], v112, s[48:51], s63 offen sc1
v_mfma_f32_16x16x32_bf16 v[92:95], a[12:15], v[36:39], v[92:95]
ds_read_b64_tr_b16 a[28:29], v121 offset:0
ds_read_b64_tr_b16 a[30:31], v121 offset:2048
s_waitcnt vmcnt(3) lgkmcnt(0)
v_add_u32 v114, 75776, v100
v_add_u32 v115, 75776, v101
v_add_u32 v116, 75776, v102
v_add_u32 v117, 75776, v103
v_mfma_f32_16x16x32_bf16 v[80:83], a[16:19], v[40:43], v[80:83]
ds_read_b64_tr_b16 a[0:1], v114 offset:0
ds_read_b64_tr_b16 a[2:3], v114 offset:2048
v_mfma_f32_16x16x32_bf16 v[84:87], a[20:23], v[40:43], v[84:87]
ds_read_b64_tr_b16 a[4:5], v115 offset:0
ds_read_b64_tr_b16 a[6:7], v115 offset:2048
v_mfma_f32_16x16x32_bf16 v[88:91], a[24:27], v[40:43], v[88:91]
ds_read_b64_tr_b16 a[8:9], v116 offset:0
ds_read_b64_tr_b16 a[10:11], v116 offset:2048
s_add_u32 s63, s71, 5120
buffer_load_dwordx4 v[56:59], v112, s[48:51], s63 offen sc1
v_mfma_f32_16x16x32_bf16 v[92:95], a[28:31], v[40:43], v[92:95]
ds_read_b64_tr_b16 a[12:13], v117 offset:0
ds_read_b64_tr_b16 a[14:15], v117 offset:2048
s_waitcnt vmcnt(3) lgkmcnt(0)
v_add_u32 v118, 79872, v100
v_add_u32 v119, 79872, v101
v_add_u32 v120, 79872, v102
v_add_u32 v121, 79872, v103
v_mfma_f32_16x16x32_bf16 v[80:83], a[0:3], v[44:47], v[80:83]
ds_read_b64_tr_b16 a[16:17], v118 offset:0
ds_read_b64_tr_b16 a[18:19], v118 offset:2048
v_mfma_f32_16x16x32_bf16 v[84:87], a[4:7], v[44:47], v[84:87]
ds_read_b64_tr_b16 a[20:21], v119 offset:0
ds_read_b64_tr_b16 a[22:23], v119 offset:2048
v_mfma_f32_16x16x32_bf16 v[88:91], a[8:11], v[44:47], v[88:91]
ds_read_b64_tr_b16 a[24:25], v120 offset:0
ds_read_b64_tr_b16 a[26:27], v120 offset:2048
s_add_u32 s63, s71, 6144
buffer_load_dwordx4 v[60:63], v112, s[48:51], s63 offen sc1
v_mfma_f32_16x16x32_bf16 v[92:95], a[12:15], v[44:47], v[92:95]
ds_read_b64_tr_b16 a[28:29], v121 offset:0
ds_read_b64_tr_b16 a[30:31], v121 offset:2048
s_waitcnt vmcnt(3) lgkmcnt(0)
v_add_u32 v114, 83968, v100
v_add_u32 v115, 83968, v101
v_add_u32 v116, 83968, v102
v_add_u32 v117, 83968, v103
v_mfma_f32_16x16x32_bf16 v[80:83], a[16:19], v[48:51], v[80:83]
ds_read_b64_tr_b16 a[0:1], v114 offset:0
ds_read_b64_tr_b16 a[2:3], v114 offset:2048
v_mfma_f32_16x16x32_bf16 v[84:87], a[20:23], v[48:51], v[84:87]
ds_read_b64_tr_b16 a[4:5], v115 offset:0
ds_read_b64_tr_b16 a[6:7], v115 offset:2048
v_mfma_f32_16x16x32_bf16 v[88:91], a[24:27], v[48:51], v[88:91]
ds_read_b64_tr_b16 a[8:9], v116 offset:0
ds_read_b64_tr_b16 a[10:11], v116 offset:2048
s_add_u32 s63, s71, 7168
buffer_load_dwordx4 v[64:67], v112, s[48:51], s63 offen sc1
v_mfma_f32_16x16x32_bf16 v[92:95], a[28:31], v[48:51], v[92:95]
ds_read_b64_tr_b16 a[12:13], v117 offset:0
ds_read_b64_tr_b16 a[14:15], v117 offset:2048
s_waitcnt vmcnt(3) lgkmcnt(0)
v_add_u32 v118, 88064, v100
v_add_u32 v119, 88064, v101
v_add_u32 v120, 88064, v102
v_add_u32 v121, 88064, v103
v_mfma_f32_16x16x32_bf16 v[80:83], a[0:3], v[52:55], v[80:83]
ds_read_b64_tr_b16 a[16:17], v118 offset:0
ds_read_b64_tr_b16 a[18:19], v118 offset:2048
v_mfma_f32_16x16x32_bf16 v[84:87], a[4:7], v[52:55], v[84:87]
ds_read_b64_tr_b16 a[20:21], v119 offset:0
ds_read_b64_tr_b16 a[22:23], v119 offset:2048
v_mfma_f32_16x16x32_bf16 v[88:91], a[8:11], v[52:55], v[88:91]
ds_read_b64_tr_b16 a[24:25], v120 offset:0
ds_read_b64_tr_b16 a[26:27], v120 offset:2048
s_add_u32 s63, s71, 8192
buffer_load_dwordx4 v[68:71], v112, s[48:51], s63 offen sc1
v_mfma_f32_16x16x32_bf16 v[92:95], a[12:15], v[52:55], v[92:95]
ds_read_b64_tr_b16 a[28:29], v121 offset:0
ds_read_b64_tr_b16 a[30:31], v121 offset:2048
s_waitcnt vmcnt(3) lgkmcnt(0)
v_add_u32 v114, 92160, v100
v_add_u32 v115, 92160, v101
v_add_u32 v116, 92160, v102
v_add_u32 v117, 92160, v103
v_mfma_f32_16x16x32_bf16 v[80:83], a[16:19], v[56:59], v[80:83]
ds_read_b64_tr_b16 a[0:1], v114 offset:0
ds_read_b64_tr_b16 a[2:3], v114 offset:2048
v_mfma_f32_16x16x32_bf16 v[84:87], a[20:23], v[56:59], v[84:87]
ds_read_b64_tr_b16 a[4:5], v115 offset:0
ds_read_b64_tr_b16 a[6:7], v115 offset:2048
v_mfma_f32_16x16x32_bf16 v[88:91], a[24:27], v[56:59], v[88:91]
ds_read_b64_tr_b16 a[8:9], v116 offset:0
ds_read_b64_tr_b16 a[10:11], v116 offset:2048
s_add_u32 s63, s71, 9216
buffer_load_dwordx4 v[72:75], v112, s[48:51], s63 offen sc1
v_mfma_f32_16x16x32_bf16 v[92:95], a[28:31], v[56:59], v[92:95]
ds_read_b64_tr_b16 a[12:13], v117 offset:0
ds_read_b64_tr_b16 a[14:15], v117 offset:2048
s_waitcnt vmcnt(3) lgkmcnt(0)
v_add_u32 v118, 96256, v100
v_add_u32 v119, 96256, v101
v_add_u32 v120, 96256, v102
v_add_u32 v121, 96256, v103
v_mfma_f32_16x16x32_bf16 v[80:83], a[0:3], v[60:63], v[80:83]
ds_read_b64_tr_b16 a[16:17], v118 offset:0
ds_read_b64_tr_b16 a[18:19], v118 offset:2048
v_mfma_f32_16x16x32_bf16 v[84:87], a[4:7], v[60:63], v[84:87]
ds_read_b64_tr_b16 a[20:21], v119 offset:0
ds_read_b64_tr_b16 a[22:23], v119 offset:2048
v_mfma_f32_16x16x32_bf16 v[88:91], a[8:11], v[60:63], v[88:91]
ds_read_b64_tr_b16 a[24:25], v120 offset:0
ds_read_b64_tr_b16 a[26:27], v120 offset:2048
s_add_u32 s63, s71, 10240
buffer_load_dwordx4 v[76:79], v112, s[48:51], s63 offen sc1
v_mfma_f32_16x16x32_bf16 v[92:95], a[12:15], v[60:63], v[92:95]
ds_read_b64_tr_b16 a[28:29], v121 offset:0
ds_read_b64_tr_b16 a[30:31], v121 offset:2048
s_waitcnt vmcnt(3) lgkmcnt(0)
v_add_u32 v114, 100352, v100
v_add_u32 v115, 100352, v101
v_add_u32 v116, 100352, v102
v_add_u32 v117, 100352, v103
v_mfma_f32_16x16x32_bf16 v[80:83], a[16:19], v[64:67], v[80:83]
ds_read_b64_tr_b16 a[0:1], v114 offset:0
ds_read_b64_tr_b16 a[2:3], v114 offset:2048
v_mfma_f32_16x16x32_bf16 v[84:87], a[20:23], v[64:67], v[84:87]
ds_read_b64_tr_b16 a[4:5], v115 offset:0
ds_read_b64_tr_b16 a[6:7], v115 offset:2048
v_mfma_f32_16x16x32_bf16 v[88:91], a[24:27], v[64:67], v[88:91]
ds_read_b64_tr_b16 a[8:9], v116 offset:0
ds_read_b64_tr_b16 a[10:11], v116 offset:2048
v_mfma_f32_16x16x32_bf16 v[92:95], a[28:31], v[64:67], v[92:95]
ds_read_b64_tr_b16 a[12:13], v117 offset:0
ds_read_b64_tr_b16 a[14:15], v117 offset:2048
s_waitcnt vmcnt(2) lgkmcnt(0)
v_add_u32 v118, 104448, v100
v_add_u32 v119, 104448, v101
v_add_u32 v120, 104448, v102
v_add_u32 v121, 104448, v103
v_mfma_f32_16x16x32_bf16 v[80:83], a[0:3], v[68:71], v[80:83]
ds_read_b64_tr_b16 a[16:17], v118 offset:0
ds_read_b64_tr_b16 a[18:19], v118 offset:2048
v_mfma_f32_16x16x32_bf16 v[84:87], a[4:7], v[68:71], v[84:87]
ds_read_b64_tr_b16 a[20:21], v119 offset:0
ds_read_b64_tr_b16 a[22:23], v119 offset:2048
v_mfma_f32_16x16x32_bf16 v[88:91], a[8:11], v[68:71], v[88:91]
ds_read_b64_tr_b16 a[24:25], v120 offset:0
ds_read_b64_tr_b16 a[26:27], v120 offset:2048
v_mfma_f32_16x16x32_bf16 v[92:95], a[12:15], v[68:71], v[92:95]
ds_read_b64_tr_b16 a[28:29], v121 offset:0
ds_read_b64_tr_b16 a[30:31], v121 offset:2048
s_waitcnt vmcnt(1) lgkmcnt(0)
v_add_u32 v114, 108544, v100
v_add_u32 v115, 108544, v101
v_add_u32 v116, 108544, v102
v_add_u32 v117, 108544, v103
v_mfma_f32_16x16x32_bf16 v[80:83], a[16:19], v[72:75], v[80:83]
ds_read_b64_tr_b16 a[0:1], v114 offset:0
ds_read_b64_tr_b16 a[2:3], v114 offset:2048
v_mfma_f32_16x16x32_bf16 v[84:87], a[20:23], v[72:75], v[84:87]
ds_read_b64_tr_b16 a[4:5], v115 offset:0
ds_read_b64_tr_b16 a[6:7], v115 offset:2048
v_mfma_f32_16x16x32_bf16 v[88:91], a[24:27], v[72:75], v[88:91]
ds_read_b64_tr_b16 a[8:9], v116 offset:0
ds_read_b64_tr_b16 a[10:11], v116 offset:2048
v_mfma_f32_16x16x32_bf16 v[92:95], a[28:31], v[72:75], v[92:95]
ds_read_b64_tr_b16 a[12:13], v117 offset:0
ds_read_b64_tr_b16 a[14:15], v117 offset:2048
s_waitcnt vmcnt(0) lgkmcnt(0)
v_mfma_f32_16x16x32_bf16 v[80:83], a[0:3], v[76:79], v[80:83]
v_mfma_f32_16x16x32_bf16 v[84:87], a[4:7], v[76:79], v[84:87]
v_mfma_f32_16x16x32_bf16 v[88:91], a[8:11], v[76:79], v[88:91]
v_mfma_f32_16x16x32_bf16 v[92:95], a[12:15], v[76:79], v[92:95]
s_branch p3join_121
p3k1_120:
s_add_u32 s63, s71, 11264
buffer_load_dwordx4 v[36:39], v112, s[48:51], s63 offen sc1
s_add_u32 s63, s71, 12288
buffer_load_dwordx4 v[40:43], v112, s[48:51], s63 offen sc1
s_add_u32 s63, s71, 13312
buffer_load_dwordx4 v[44:47], v112, s[48:51], s63 offen sc1
v_add_u32 v114, 112640, v100
v_add_u32 v115, 112640, v101
v_add_u32 v116, 112640, v102
v_add_u32 v117, 112640, v103
ds_read_b64_tr_b16 a[0:1], v114 offset:0
ds_read_b64_tr_b16 a[2:3], v114 offset:2048
ds_read_b64_tr_b16 a[4:5], v115 offset:0
ds_read_b64_tr_b16 a[6:7], v115 offset:2048
ds_read_b64_tr_b16 a[8:9], v116 offset:0
ds_read_b64_tr_b16 a[10:11], v116 offset:2048
ds_read_b64_tr_b16 a[12:13], v117 offset:0
ds_read_b64_tr_b16 a[14:15], v117 offset:2048
s_add_u32 s63, s71, 14336
buffer_load_dwordx4 v[48:51], v112, s[48:51], s63 offen sc1
s_waitcnt vmcnt(3) lgkmcnt(0)
v_add_u32 v118, 116736, v100
v_add_u32 v119, 116736, v101
v_add_u32 v120, 116736, v102
v_add_u32 v121, 116736, v103
v_mfma_f32_16x16x32_bf16 v[80:83], a[0:3], v[36:39], v[80:83]
ds_read_b64_tr_b16 a[16:17], v118 offset:0
ds_read_b64_tr_b16 a[18:19], v118 offset:2048
v_mfma_f32_16x16x32_bf16 v[84:87], a[4:7], v[36:39], v[84:87]
ds_read_b64_tr_b16 a[20:21], v119 offset:0
ds_read_b64_tr_b16 a[22:23], v119 offset:2048
v_mfma_f32_16x16x32_bf16 v[88:91], a[8:11], v[36:39], v[88:91]
ds_read_b64_tr_b16 a[24:25], v120 offset:0
ds_read_b64_tr_b16 a[26:27], v120 offset:2048
s_add_u32 s63, s71, 15360
buffer_load_dwordx4 v[52:55], v112, s[48:51], s63 offen sc1
v_mfma_f32_16x16x32_bf16 v[92:95], a[12:15], v[36:39], v[92:95]
ds_read_b64_tr_b16 a[28:29], v121 offset:0
ds_read_b64_tr_b16 a[30:31], v121 offset:2048
s_waitcnt vmcnt(3) lgkmcnt(0)
v_add_u32 v114, 120832, v100
v_add_u32 v115, 120832, v101
v_add_u32 v116, 120832, v102
v_add_u32 v117, 120832, v103
v_mfma_f32_16x16x32_bf16 v[80:83], a[16:19], v[40:43], v[80:83]
ds_read_b64_tr_b16 a[0:1], v114 offset:0
ds_read_b64_tr_b16 a[2:3], v114 offset:2048
v_mfma_f32_16x16x32_bf16 v[84:87], a[20:23], v[40:43], v[84:87]
ds_read_b64_tr_b16 a[4:5], v115 offset:0
ds_read_b64_tr_b16 a[6:7], v115 offset:2048
v_mfma_f32_16x16x32_bf16 v[88:91], a[24:27], v[40:43], v[88:91]
ds_read_b64_tr_b16 a[8:9], v116 offset:0
ds_read_b64_tr_b16 a[10:11], v116 offset:2048
s_add_u32 s63, s71, 16384
buffer_load_dwordx4 v[56:59], v112, s[48:51], s63 offen sc1
v_mfma_f32_16x16x32_bf16 v[92:95], a[28:31], v[40:43], v[92:95]
ds_read_b64_tr_b16 a[12:13], v117 offset:0
ds_read_b64_tr_b16 a[14:15], v117 offset:2048
s_waitcnt vmcnt(3) lgkmcnt(0)
v_add_u32 v118, 124928, v100
v_add_u32 v119, 124928, v101
v_add_u32 v120, 124928, v102
v_add_u32 v121, 124928, v103
v_mfma_f32_16x16x32_bf16 v[80:83], a[0:3], v[44:47], v[80:83]
ds_read_b64_tr_b16 a[16:17], v118 offset:0
ds_read_b64_tr_b16 a[18:19], v118 offset:2048
v_mfma_f32_16x16x32_bf16 v[84:87], a[4:7], v[44:47], v[84:87]
ds_read_b64_tr_b16 a[20:21], v119 offset:0
ds_read_b64_tr_b16 a[22:23], v119 offset:2048
v_mfma_f32_16x16x32_bf16 v[88:91], a[8:11], v[44:47], v[88:91]
ds_read_b64_tr_b16 a[24:25], v120 offset:0
ds_read_b64_tr_b16 a[26:27], v120 offset:2048
s_add_u32 s63, s71, 17408
buffer_load_dwordx4 v[60:63], v112, s[48:51], s63 offen sc1
v_mfma_f32_16x16x32_bf16 v[92:95], a[12:15], v[44:47], v[92:95]
ds_read_b64_tr_b16 a[28:29], v121 offset:0
ds_read_b64_tr_b16 a[30:31], v121 offset:2048
s_waitcnt vmcnt(3) lgkmcnt(0)
v_add_u32 v114, 129024, v100
v_add_u32 v115, 129024, v101
v_add_u32 v116, 129024, v102
v_add_u32 v117, 129024, v103
v_mfma_f32_16x16x32_bf16 v[80:83], a[16:19], v[48:51], v[80:83]
ds_read_b64_tr_b16 a[0:1], v114 offset:0
ds_read_b64_tr_b16 a[2:3], v114 offset:2048
v_mfma_f32_16x16x32_bf16 v[84:87], a[20:23], v[48:51], v[84:87]
ds_read_b64_tr_b16 a[4:5], v115 offset:0
ds_read_b64_tr_b16 a[6:7], v115 offset:2048
v_mfma_f32_16x16x32_bf16 v[88:91], a[24:27], v[48:51], v[88:91]
ds_read_b64_tr_b16 a[8:9], v116 offset:0
ds_read_b64_tr_b16 a[10:11], v116 offset:2048
s_add_u32 s63, s71, 18432
buffer_load_dwordx4 v[64:67], v112, s[48:51], s63 offen sc1
v_mfma_f32_16x16x32_bf16 v[92:95], a[28:31], v[48:51], v[92:95]
ds_read_b64_tr_b16 a[12:13], v117 offset:0
ds_read_b64_tr_b16 a[14:15], v117 offset:2048
s_waitcnt vmcnt(3) lgkmcnt(0)
v_add_u32 v118, 133120, v100
v_add_u32 v119, 133120, v101
v_add_u32 v120, 133120, v102
v_add_u32 v121, 133120, v103
v_mfma_f32_16x16x32_bf16 v[80:83], a[0:3], v[52:55], v[80:83]
ds_read_b64_tr_b16 a[16:17], v118 offset:0
ds_read_b64_tr_b16 a[18:19], v118 offset:2048
v_mfma_f32_16x16x32_bf16 v[84:87], a[4:7], v[52:55], v[84:87]
ds_read_b64_tr_b16 a[20:21], v119 offset:0
ds_read_b64_tr_b16 a[22:23], v119 offset:2048
v_mfma_f32_16x16x32_bf16 v[88:91], a[8:11], v[52:55], v[88:91]
ds_read_b64_tr_b16 a[24:25], v120 offset:0
ds_read_b64_tr_b16 a[26:27], v120 offset:2048
s_add_u32 s63, s71, 19456
buffer_load_dwordx4 v[68:71], v112, s[48:51], s63 offen sc1
v_mfma_f32_16x16x32_bf16 v[92:95], a[12:15], v[52:55], v[92:95]
ds_read_b64_tr_b16 a[28:29], v121 offset:0
ds_read_b64_tr_b16 a[30:31], v121 offset:2048
s_waitcnt vmcnt(3) lgkmcnt(0)
v_add_u32 v114, 137216, v100
v_add_u32 v115, 137216, v101
v_add_u32 v116, 137216, v102
v_add_u32 v117, 137216, v103
v_mfma_f32_16x16x32_bf16 v[80:83], a[16:19], v[56:59], v[80:83]
ds_read_b64_tr_b16 a[0:1], v114 offset:0
ds_read_b64_tr_b16 a[2:3], v114 offset:2048
v_mfma_f32_16x16x32_bf16 v[84:87], a[20:23], v[56:59], v[84:87]
ds_read_b64_tr_b16 a[4:5], v115 offset:0
ds_read_b64_tr_b16 a[6:7], v115 offset:2048
v_mfma_f32_16x16x32_bf16 v[88:91], a[24:27], v[56:59], v[88:91]
ds_read_b64_tr_b16 a[8:9], v116 offset:0
ds_read_b64_tr_b16 a[10:11], v116 offset:2048
s_add_u32 s63, s71, 20480
buffer_load_dwordx4 v[72:75], v112, s[48:51], s63 offen sc1
v_mfma_f32_16x16x32_bf16 v[92:95], a[28:31], v[56:59], v[92:95]
ds_read_b64_tr_b16 a[12:13], v117 offset:0
ds_read_b64_tr_b16 a[14:15], v117 offset:2048
s_waitcnt vmcnt(3) lgkmcnt(0)
v_add_u32 v118, 141312, v100
v_add_u32 v119, 141312, v101
v_add_u32 v120, 141312, v102
v_add_u32 v121, 141312, v103
v_mfma_f32_16x16x32_bf16 v[80:83], a[0:3], v[60:63], v[80:83]
ds_read_b64_tr_b16 a[16:17], v118 offset:0
ds_read_b64_tr_b16 a[18:19], v118 offset:2048
v_mfma_f32_16x16x32_bf16 v[84:87], a[4:7], v[60:63], v[84:87]
ds_read_b64_tr_b16 a[20:21], v119 offset:0
ds_read_b64_tr_b16 a[22:23], v119 offset:2048
v_mfma_f32_16x16x32_bf16 v[88:91], a[8:11], v[60:63], v[88:91]
ds_read_b64_tr_b16 a[24:25], v120 offset:0
ds_read_b64_tr_b16 a[26:27], v120 offset:2048
buffer_load_dwordx2 v[76:77], v113, s[48:51], s72 offen sc1
v_mfma_f32_16x16x32_bf16 v[92:95], a[12:15], v[60:63], v[92:95]
ds_read_b64_tr_b16 a[28:29], v121 offset:0
ds_read_b64_tr_b16 a[30:31], v121 offset:2048
s_waitcnt vmcnt(3) lgkmcnt(0)
v_add_u32 v114, 145408, v100
v_add_u32 v115, 145408, v101
v_add_u32 v116, 145408, v102
v_add_u32 v117, 145408, v103
v_mfma_f32_16x16x32_bf16 v[80:83], a[16:19], v[64:67], v[80:83]
ds_read_b64_tr_b16 a[0:1], v114 offset:0
ds_read_b64_tr_b16 a[2:3], v114 offset:2048
v_mfma_f32_16x16x32_bf16 v[84:87], a[20:23], v[64:67], v[84:87]
ds_read_b64_tr_b16 a[4:5], v115 offset:0
ds_read_b64_tr_b16 a[6:7], v115 offset:2048
v_mfma_f32_16x16x32_bf16 v[88:91], a[24:27], v[64:67], v[88:91]
ds_read_b64_tr_b16 a[8:9], v116 offset:0
ds_read_b64_tr_b16 a[10:11], v116 offset:2048
v_mfma_f32_16x16x32_bf16 v[92:95], a[28:31], v[64:67], v[92:95]
ds_read_b64_tr_b16 a[12:13], v117 offset:0
ds_read_b64_tr_b16 a[14:15], v117 offset:2048
s_waitcnt vmcnt(2) lgkmcnt(0)
v_add_u32 v118, 149504, v100
v_add_u32 v119, 149504, v101
v_add_u32 v120, 149504, v102
v_add_u32 v121, 149504, v103
v_mfma_f32_16x16x32_bf16 v[80:83], a[0:3], v[68:71], v[80:83]
ds_read_b64_tr_b16 a[16:17], v118 offset:0
ds_read_b64_tr_b16 a[18:19], v118 offset:2048
v_mfma_f32_16x16x32_bf16 v[84:87], a[4:7], v[68:71], v[84:87]
ds_read_b64_tr_b16 a[20:21], v119 offset:0
ds_read_b64_tr_b16 a[22:23], v119 offset:2048
v_mfma_f32_16x16x32_bf16 v[88:91], a[8:11], v[68:71], v[88:91]
ds_read_b64_tr_b16 a[24:25], v120 offset:0
ds_read_b64_tr_b16 a[26:27], v120 offset:2048
v_mfma_f32_16x16x32_bf16 v[92:95], a[12:15], v[68:71], v[92:95]
ds_read_b64_tr_b16 a[28:29], v121 offset:0
ds_read_b64_tr_b16 a[30:31], v121 offset:2048
s_waitcnt vmcnt(1) lgkmcnt(0)
v_add_u32 v114, 65536, v100
v_add_u32 v115, 65536, v101
v_add_u32 v116, 65536, v102
v_add_u32 v117, 65536, v103
v_mfma_f32_16x16x32_bf16 v[80:83], a[16:19], v[72:75], v[80:83]
ds_read_b64_tr_b16 a[0:1], v114 offset:0
ds_read_b64_tr_b16 a[4:5], v115 offset:0
v_mfma_f32_16x16x32_bf16 v[84:87], a[20:23], v[72:75], v[84:87]
ds_read_b64_tr_b16 a[8:9], v116 offset:0
ds_read_b64_tr_b16 a[12:13], v117 offset:0
v_mfma_f32_16x16x32_bf16 v[88:91], a[24:27], v[72:75], v[88:91]
v_mfma_f32_16x16x32_bf16 v[92:95], a[28:31], v[72:75], v[92:95]
s_waitcnt vmcnt(0) lgkmcnt(0)
v_mfma_f32_16x16x16_bf16 v[80:83], a[0:1], v[76:77], v[80:83]
v_mfma_f32_16x16x16_bf16 v[84:87], a[4:5], v[76:77], v[84:87]
v_mfma_f32_16x16x16_bf16 v[88:91], a[8:9], v[76:77], v[88:91]
v_mfma_f32_16x16x16_bf16 v[92:95], a[12:13], v[76:77], v[92:95]
p3join_121:
s_barrier
s_lshl_b32 s60, s7, 12
s_lshl_b32 s61, s8, 11
s_add_u32 s60, s60, s61
v_add_u32 v114, s60, v112
s_xor_b32 s61, s60, 2048
v_add_u32 v115, s61, v112
s_cmp_lg_u32 s8, 0
s_cbranch_scc1 r0_122
ds_write_b128 v114, v[88:91] offset:0
ds_write_b128 v114, v[92:95] offset:1024
s_branch r1_123
r0_122:
ds_write_b128 v114, v[80:83] offset:0
ds_write_b128 v114, v[84:87] offset:1024
v_mov_b32 v80, v88
v_mov_b32 v81, v89
v_mov_b32 v82, v90
v_mov_b32 v83, v91
v_mov_b32 v84, v92
v_mov_b32 v85, v93
v_mov_b32 v86, v94
v_mov_b32 v87, v95
r1_123:
s_mov_b32 s56, s34
s_and_b32 s57, s35, 0xffff
s_mov_b32 s58, 0x200000
s_mov_b32 s59, 0x00020000
v_and_b32 v116, 15, v0
v_lshlrev_b32 v116, 10, v116
v_bfe_u32 v117, v0, 4, 1
v_lshl_add_u32 v116, v117, 5, v116
v_lshrrev_b32 v117, 5, v0
v_lshl_add_u32 v116, v117, 4, v116
s_lshl_b32 s60, s11, 14
s_lshl_b32 s61, s10, 7
s_add_u32 s60, s60, s61
s_lshl_b32 s61, s8, 6
s_add_u32 s60, s60, s61
s_waitcnt lgkmcnt(0)
s_barrier
ds_read_b128 v[4:7], v115 offset:0
ds_read_b128 v[8:11], v115 offset:1024
s_waitcnt lgkmcnt(0)
v_pk_add_f32 v[80:81], v[80:81], v[4:5]
v_pk_add_f32 v[82:83], v[82:83], v[6:7]
v_pk_add_f32 v[84:85], v[84:85], v[8:9]
v_pk_add_f32 v[86:87], v[86:87], v[10:11]
v_cvt_pk_bf16_f32 v12, v80, v81
v_cvt_pk_bf16_f32 v13, v82, v83
v_cvt_pk_bf16_f32 v14, v84, v85
v_cvt_pk_bf16_f32 v15, v86, v87
s_nop 0
v_permlane16_swap_b32 v12, v14
v_permlane16_swap_b32 v13, v15
buffer_store_dwordx4 v[12:15], v116, s[56:59], s60 offen sc1
k_exit:
s_endpgm
k_code_end:
.section .rodata,"a"
.p2align 6
.amdhsa_kernel gated_mix__linear_attn_block__mixer_gmlp__prompt_kernel
  .amdhsa_next_free_vgpr 256
  .amdhsa_next_free_sgpr 102
  .amdhsa_accum_offset 128
  .amdhsa_group_segment_fixed_size 0
  .amdhsa_kernarg_size 96
  .amdhsa_user_sgpr_count 2
  .amdhsa_user_sgpr_kernarg_segment_ptr 1
  .amdhsa_system_sgpr_workgroup_id_x 1
  .amdhsa_float_denorm_mode_32 3
.end_amdhsa_kernel
```
